```python
import torch

def _softmax(x, axis=-1):
    return torch.softmax(x, dim=axis)
def _gelu(x):
    return torch.nn.functional.gelu(x, approximate="tanh")
def _silu(x):
    return torch.nn.functional.silu(x)
def _sigmoid(x):
    return torch.sigmoid(x)
def _layernorm(x, axis=-1, eps=1e-5):
    m = x.mean(dim=axis, keepdim=True)
    v = x.var(dim=axis, keepdim=True, unbiased=False)
    return (x - m) / torch.sqrt(v + eps)
def _scatter_add(tgt, idx, src, axis=0):
    return tgt.clone().index_add_(axis, idx, src)
def _segment_sum(src, seg, n):
    out = torch.zeros((n,) + src.shape[1:], dtype=src.dtype)
    return out.index_add_(0, seg, src)
def _pad(x, pw):
    flat = tuple(v for pair in reversed(pw) for v in pair)
    return torch.nn.functional.pad(x, flat)

kernel_name = 'gated_mix__ssm_conv_s5__dense_activation_gelu__prompt'

def setup_inputs():

    _w = (lambda a: (lambda t: t.to(torch.bfloat16) if t.is_floating_point() else t)(torch.as_tensor(a)))
    def _A_setup():
        B, S, D = 1, 2048, 512
        P = D
        Lambda_re = -0.5 * (lambda _x: torch.exp(torch.as_tensor(_x)))((lambda *s: torch.randn(*s, dtype=torch.bfloat16) * 0.2)(P))
        Lambda_im = (lambda *s: torch.randn(*s, dtype=torch.bfloat16) * 0.8)(P) * 1.0
        B_re = (lambda *s: torch.randn(*s, dtype=torch.bfloat16) * 0.2)(P, D) * (D ** -0.5)
        B_im = (lambda *s: torch.randn(*s, dtype=torch.bfloat16) * 0.2)(P, D) * (D ** -0.5)
        C_re = (lambda *s: torch.randn(*s, dtype=torch.bfloat16) * 0.2)(D, P) * (P ** -0.5)
        C_im = (lambda *s: torch.randn(*s, dtype=torch.bfloat16) * 0.2)(D, P) * (P ** -0.5)
        log_dt = (lambda *s: torch.randn(*s, dtype=torch.bfloat16) * 0.2)(P) * 0.3 - 2.0
        Dskip = (lambda *s: torch.randn(*s, dtype=torch.bfloat16) * 0.05)(D)
        return {
            "x": _w((lambda *s: torch.randn(*s, dtype=torch.bfloat16) * 0.05)(B, S, D)),
            "Lambda_re": _w(Lambda_re),
            "Lambda_im": _w(Lambda_im),
            "B_re": _w(B_re),
            "B_im": _w(B_im),
            "C_re": _w(C_re),
            "C_im": _w(C_im),
            "log_dt": _w(log_dt),
            "Dskip": _w(Dskip),
        }
    _A_in = _A_setup()

    def _B_setup():
        B, S, D, F = 1, 2048, 512, 1792
        return {
            "x": _w((lambda *s: torch.randn(*s, dtype=torch.bfloat16) * 0.05)(B, S, D)),
            "w1": _w((lambda *s: torch.randn(*s, dtype=torch.bfloat16) * 3.2)(D, F) * (D ** -0.5)),
            "b1": _w((lambda *s: torch.randn(*s, dtype=torch.bfloat16) * 3.2)(F) * 0.01),
            "w2": _w((lambda *s: torch.randn(*s, dtype=torch.bfloat16) * 0.1)(F, D) * (F ** -0.5)),
            "b2": _w((lambda *s: torch.randn(*s, dtype=torch.bfloat16) * 0.2)(D) * 0.01),
        }
    _B_in = _B_setup()

    return {
        "A_x": _A_in["x"],
        "A_Lambda_re": _A_in["Lambda_re"],
        "A_Lambda_im": _A_in["Lambda_im"],
        "A_B_re": _A_in["B_re"],
        "A_B_im": _A_in["B_im"],
        "A_C_re": _A_in["C_re"],
        "A_C_im": _A_in["C_im"],
        "A_log_dt": _A_in["log_dt"],
        "A_Dskip": _A_in["Dskip"],
        "B_x": _B_in["x"],
        "B_w1": _B_in["w1"],
        "B_b1": _B_in["b1"],
        "B_w2": _B_in["w2"],
        "B_b2": _B_in["b2"],
        "gate_w": _w((lambda *s: torch.randn(*s, dtype=torch.bfloat16) * 0.05)(512) * 16.0),
    }

def reference(A_x, A_Lambda_re, A_Lambda_im, A_B_re, A_B_im, A_C_re, A_C_im, A_log_dt, A_Dskip, B_x, B_w1, B_b1, B_w2, B_b2, gate_w):
    def _A_ref(x, Lambda_re, Lambda_im, B_re, B_im, C_re, C_im, log_dt, Dskip):
        Bsz, L, H = x.shape
        Lam = Lambda_re + 1j * Lambda_im
        Bmat = B_re + 1j * B_im
        Cmat = C_re + 1j * C_im
        dt = torch.exp(log_dt)
        Lam_bar = torch.exp(dt * Lam)
        B_bar = ((Lam_bar - 1.0) / Lam)[:, None] * Bmat
        Bu = torch.einsum("bld,pd->blp", x + 0j, B_bar)
        h = torch.zeros_like(Bu[:, 0, :])
        hs = []
        for t in range(L):
            h = Lam_bar[None, :] * h + Bu[:, t, :]
            hs.append(h)
        hseq = torch.stack(hs, 1)
        y = 2.0 * torch.einsum("blp,dp->bld", hseq, Cmat).real + x * Dskip[None, None, :]
        return y

    def _B_ref(x, w1, b1, w2, b2):
        h = torch.einsum("bsd,df->bsf", x, w1) + b1
        h = _gelu(h)
        return torch.einsum("bsf,fd->bsd", h, w2) + b2

    x = A_x
    g = _sigmoid((x * gate_w).sum(-1, keepdims=True))
    a = _A_ref(x, A_Lambda_re, A_Lambda_im, A_B_re, A_B_im, A_C_re, A_C_im, A_log_dt, A_Dskip)
    b = _B_ref(x, B_w1, B_b1, B_w2, B_b2)
    return g * a + (1 - g) * b
```

```asm
; @launch kernel=k1_kernel grid=(256,1,1) block=(512,1,1) lds=135168
; @launch kernel=k2_kernel grid=(256,1,1) block=(512,1,1) lds=131072
.amdgcn_target "amdgcn-amd-amdhsa--gfx950"
.text
.globl k1_kernel
.p2align 8
.type k1_kernel,@function
k1_kernel:
    s_cmp_ge_u32 s2, 256
    s_cbranch_scc1 K1_END
    s_load_dwordx4 s[24:27], s[0:1], 0
    s_load_dwordx4 s[28:31], s[0:1], 16
    s_load_dwordx2 s[32:33], s[0:1], 32
    s_load_dwordx2 s[34:35], s[0:1], 56
    s_load_dwordx4 s[36:39], s[0:1], 80
    s_load_dwordx2 s[40:41], s[0:1], 112
    s_load_dwordx2 s[42:43], s[0:1], 128
    s_load_dwordx2 s[44:45], s[0:1], 136
    s_lshr_b32 s3, s2, 4
    s_and_b32 s4, s2, 15
    v_lshrrev_b32 v1, 6, v0
    s_nop 0
    v_readfirstlane_b32 s5, v1
    v_and_b32 v2, 63, v0
    v_and_b32 v3, 15, v0
    v_bfe_u32 v4, v0, 4, 2
    s_lshl_b32 s6, s3, 17
    s_waitcnt lgkmcnt(0)
    s_mov_b32 s8, s24
    s_mov_b32 s9, s25
    s_mov_b32 s10, 2097152
    s_mov_b32 s11, 0x00020000
    s_mov_b32 s20, s44
    s_mov_b32 s21, s45
    s_mov_b32 s22, 16777216
    s_mov_b32 s23, 0x00020000
    v_lshrrev_b32 v8, 3, v2
    v_and_b32 v9, 7, v2
    v_xor_b32 v10, v8, v9
    s_lshl_b32 s7, s5, 4
    v_add_u32 v11, s7, v8
    v_lshlrev_b32 v5, 10, v11
    v_lshl_add_u32 v5, v10, 4, v5
    v_mov_b32 v7, v5
    v_add_u32 v5, s6, v5
    v_add_u32 v6, 8192, v5
    s_lshl_b32 s58, s5, 11
    s_and_b32 s49, s5, 2
    s_lshr_b32 s49, s49, 1
    s_and_b32 s50, s5, 1
    s_lshr_b32 s61, s5, 2
    s_lshl_b32 s51, s61, 2
    v_add_u32 v12, s51, v4
    v_and_b32 v13, 7, v3
    v_xor_b32 v12, v12, v13
    s_lshl_b32 s51, s49, 6
    v_add_u32 v13, s51, v3
    v_lshlrev_b32 v28, 7, v13
    v_lshl_add_u32 v28, v12, 4, v28
    v_add_u32 v29, 90112, v28
    s_cmp_lt_u32 s4, 8
    s_cbranch_scc1 K1_SSM
    s_sub_u32 s7, s4, 8
    s_mul_i32 s7, s7, 448
    s_mov_b32 s12, s36
    s_mov_b32 s13, s37
    s_mov_b32 s14, 1835008
    s_mov_b32 s15, 0x00020000
    s_mov_b32 s48, 2341
    s_lshl_b32 s51, s5, 6
    s_add_u32 s51, s51, 0
    s_lshl_b32 s64, s51, 4
    v_add_u32 v10, s51, v2
    v_mul_lo_u32 v11, v10, s48
    v_lshrrev_b32 v11, 16, v11
    v_mul_u32_u24 v12, 28, v11
    v_sub_u32 v12, v10, v12
    v_bfe_u32 v13, v11, 3, 1
    v_lshlrev_b32 v13, 1, v13
    v_xor_b32 v12, v12, v13
    v_mul_u32_u24 v13, 3584, v11
    v_lshl_add_u32 v20, v12, 4, v13
    v_add_u32 v20, s7, v20
    s_lshl_b32 s51, s5, 6
    s_add_u32 s51, s51, 512
    s_lshl_b32 s65, s51, 4
    v_add_u32 v10, s51, v2
    v_mul_lo_u32 v11, v10, s48
    v_lshrrev_b32 v11, 16, v11
    v_mul_u32_u24 v12, 28, v11
    v_sub_u32 v12, v10, v12
    v_bfe_u32 v13, v11, 3, 1
    v_lshlrev_b32 v13, 1, v13
    v_xor_b32 v12, v12, v13
    v_mul_u32_u24 v13, 3584, v11
    v_lshl_add_u32 v21, v12, 4, v13
    v_add_u32 v21, s7, v21
    s_lshl_b32 s51, s5, 6
    s_add_u32 s51, s51, 1024
    s_lshl_b32 s66, s51, 4
    v_add_u32 v10, s51, v2
    v_mul_lo_u32 v11, v10, s48
    v_lshrrev_b32 v11, 16, v11
    v_mul_u32_u24 v12, 28, v11
    v_sub_u32 v12, v10, v12
    v_bfe_u32 v13, v11, 3, 1
    v_lshlrev_b32 v13, 1, v13
    v_xor_b32 v12, v12, v13
    v_mul_u32_u24 v13, 3584, v11
    v_lshl_add_u32 v22, v12, 4, v13
    v_add_u32 v22, s7, v22
    s_lshl_b32 s51, s5, 6
    s_add_u32 s51, s51, 1536
    s_cmp_ge_u32 s51, 1792
    s_cselect_b32 s52, 512, 0
    s_sub_u32 s51, s51, s52
    s_lshl_b32 s67, s51, 4
    v_add_u32 v10, s51, v2
    v_mul_lo_u32 v11, v10, s48
    v_lshrrev_b32 v11, 16, v11
    v_mul_u32_u24 v12, 28, v11
    v_sub_u32 v12, v10, v12
    v_bfe_u32 v13, v11, 3, 1
    v_lshlrev_b32 v13, 1, v13
    v_xor_b32 v12, v12, v13
    v_mul_u32_u24 v13, 3584, v11
    v_lshl_add_u32 v23, v12, 4, v13
    v_add_u32 v23, s7, v23
    v_lshrrev_b32 v10, 2, v3
    v_lshl_add_u32 v10, v4, 3, v10
    s_lshl_b32 s51, s61, 5
    v_add_u32 v10, s51, v10
    v_mul_u32_u24 v11, 448, v10
    v_and_b32 v12, 3, v3
    v_lshl_add_u32 v11, v12, 3, v11
    s_mul_i32 s51, s50, 224
    s_add_u32 s51, s51, 16384
    v_add_u32 v11, s51, v11
    v_and_b32 v12, 1, v4
    v_lshlrev_b32 v12, 5, v12
    s_cmp_eq_u32 s50, 0
    s_cselect_b32 s51, 1, -1
    v_mul_lo_u32 v12, v12, s51
    v_add_u32 v30, v11, v12
    v_sub_u32 v31, v11, v12
    v_add_u32 v32, 90112, v30
    v_add_u32 v33, 90112, v31
    v_accvgpr_write_b32 a0, 0
    v_accvgpr_write_b32 a1, 0
    v_accvgpr_write_b32 a2, 0
    v_accvgpr_write_b32 a3, 0
    v_accvgpr_write_b32 a4, 0
    v_accvgpr_write_b32 a5, 0
    v_accvgpr_write_b32 a6, 0
    v_accvgpr_write_b32 a7, 0
    v_accvgpr_write_b32 a8, 0
    v_accvgpr_write_b32 a9, 0
    v_accvgpr_write_b32 a10, 0
    v_accvgpr_write_b32 a11, 0
    v_accvgpr_write_b32 a12, 0
    v_accvgpr_write_b32 a13, 0
    v_accvgpr_write_b32 a14, 0
    v_accvgpr_write_b32 a15, 0
    v_accvgpr_write_b32 a16, 0
    v_accvgpr_write_b32 a17, 0
    v_accvgpr_write_b32 a18, 0
    v_accvgpr_write_b32 a19, 0
    v_accvgpr_write_b32 a20, 0
    v_accvgpr_write_b32 a21, 0
    v_accvgpr_write_b32 a22, 0
    v_accvgpr_write_b32 a23, 0
    v_accvgpr_write_b32 a24, 0
    v_accvgpr_write_b32 a25, 0
    v_accvgpr_write_b32 a26, 0
    v_accvgpr_write_b32 a27, 0
    v_accvgpr_write_b32 a28, 0
    v_accvgpr_write_b32 a29, 0
    v_accvgpr_write_b32 a30, 0
    v_accvgpr_write_b32 a31, 0
    v_accvgpr_write_b32 a32, 0
    v_accvgpr_write_b32 a33, 0
    v_accvgpr_write_b32 a34, 0
    v_accvgpr_write_b32 a35, 0
    v_accvgpr_write_b32 a36, 0
    v_accvgpr_write_b32 a37, 0
    v_accvgpr_write_b32 a38, 0
    v_accvgpr_write_b32 a39, 0
    v_accvgpr_write_b32 a40, 0
    v_accvgpr_write_b32 a41, 0
    v_accvgpr_write_b32 a42, 0
    v_accvgpr_write_b32 a43, 0
    v_accvgpr_write_b32 a44, 0
    v_accvgpr_write_b32 a45, 0
    v_accvgpr_write_b32 a46, 0
    v_accvgpr_write_b32 a47, 0
    v_accvgpr_write_b32 a48, 0
    v_accvgpr_write_b32 a49, 0
    v_accvgpr_write_b32 a50, 0
    v_accvgpr_write_b32 a51, 0
    v_accvgpr_write_b32 a52, 0
    v_accvgpr_write_b32 a53, 0
    v_accvgpr_write_b32 a54, 0
    v_accvgpr_write_b32 a55, 0
    v_accvgpr_write_b32 a56, 0
    v_accvgpr_write_b32 a57, 0
    v_accvgpr_write_b32 a58, 0
    v_accvgpr_write_b32 a59, 0
    v_accvgpr_write_b32 a60, 0
    v_accvgpr_write_b32 a61, 0
    v_accvgpr_write_b32 a62, 0
    v_accvgpr_write_b32 a63, 0
    v_accvgpr_write_b32 a64, 0
    v_accvgpr_write_b32 a65, 0
    v_accvgpr_write_b32 a66, 0
    v_accvgpr_write_b32 a67, 0
    v_accvgpr_write_b32 a68, 0
    v_accvgpr_write_b32 a69, 0
    v_accvgpr_write_b32 a70, 0
    v_accvgpr_write_b32 a71, 0
    v_accvgpr_write_b32 a72, 0
    v_accvgpr_write_b32 a73, 0
    v_accvgpr_write_b32 a74, 0
    v_accvgpr_write_b32 a75, 0
    v_accvgpr_write_b32 a76, 0
    v_accvgpr_write_b32 a77, 0
    v_accvgpr_write_b32 a78, 0
    v_accvgpr_write_b32 a79, 0
    v_accvgpr_write_b32 a80, 0
    v_accvgpr_write_b32 a81, 0
    v_accvgpr_write_b32 a82, 0
    v_accvgpr_write_b32 a83, 0
    v_accvgpr_write_b32 a84, 0
    v_accvgpr_write_b32 a85, 0
    v_accvgpr_write_b32 a86, 0
    v_accvgpr_write_b32 a87, 0
    v_accvgpr_write_b32 a88, 0
    v_accvgpr_write_b32 a89, 0
    v_accvgpr_write_b32 a90, 0
    v_accvgpr_write_b32 a91, 0
    v_accvgpr_write_b32 a92, 0
    v_accvgpr_write_b32 a93, 0
    v_accvgpr_write_b32 a94, 0
    v_accvgpr_write_b32 a95, 0
    v_accvgpr_write_b32 a96, 0
    v_accvgpr_write_b32 a97, 0
    v_accvgpr_write_b32 a98, 0
    v_accvgpr_write_b32 a99, 0
    v_accvgpr_write_b32 a100, 0
    v_accvgpr_write_b32 a101, 0
    v_accvgpr_write_b32 a102, 0
    v_accvgpr_write_b32 a103, 0
    v_accvgpr_write_b32 a104, 0
    v_accvgpr_write_b32 a105, 0
    v_accvgpr_write_b32 a106, 0
    v_accvgpr_write_b32 a107, 0
    v_accvgpr_write_b32 a108, 0
    v_accvgpr_write_b32 a109, 0
    v_accvgpr_write_b32 a110, 0
    v_accvgpr_write_b32 a111, 0
    s_mov_b32 s76, s38
    s_mov_b32 s77, s39
    s_mov_b32 s78, 3584
    s_mov_b32 s79, 0x00020000
    v_lshlrev_b32 v14, 3, v4
    s_mul_i32 s51, s50, 224
    s_add_u32 s51, s51, s7
    v_add_u32 v14, s51, v14
    buffer_load_dwordx2 v[118:119], v14, s[76:79], 0 offen offset:0
    buffer_load_dwordx2 v[120:121], v14, s[76:79], 0 offen offset:32
    buffer_load_dwordx2 v[122:123], v14, s[76:79], 0 offen offset:64
    buffer_load_dwordx2 v[124:125], v14, s[76:79], 0 offen offset:96
    buffer_load_dwordx2 v[126:127], v14, s[76:79], 0 offen offset:128
    buffer_load_dwordx2 v[128:129], v14, s[76:79], 0 offen offset:160
    buffer_load_dwordx2 v[130:131], v14, s[76:79], 0 offen offset:192
    s_mov_b32 s46, 0
    s_mov_b32 s47, 0
    s_add_u32 s59, s58, 0
    s_mov_b32 m0, s59
    s_nop 0
    buffer_load_dwordx4 v5, s[8:11], s46 offen lds
    s_add_u32 s59, s58, 1024
    s_mov_b32 m0, s59
    s_nop 0
    buffer_load_dwordx4 v6, s[8:11], s46 offen lds
    s_add_u32 s59, s64, 16384
    s_mov_b32 m0, s59
    s_nop 0
    buffer_load_dwordx4 v20, s[12:15], s47 offen lds
    s_add_u32 s59, s65, 16384
    s_mov_b32 m0, s59
    s_nop 0
    buffer_load_dwordx4 v21, s[12:15], s47 offen lds
    s_add_u32 s59, s66, 16384
    s_mov_b32 m0, s59
    s_nop 0
    buffer_load_dwordx4 v22, s[12:15], s47 offen lds
    s_add_u32 s59, s67, 16384
    s_mov_b32 m0, s59
    s_nop 0
    buffer_load_dwordx4 v23, s[12:15], s47 offen lds
    s_mov_b32 s46, 128
    s_mov_b32 s47, 229376
    s_add_u32 s59, s58, 45056
    s_mov_b32 m0, s59
    s_nop 0
    buffer_load_dwordx4 v5, s[8:11], s46 offen lds
    s_add_u32 s59, s58, 46080
    s_mov_b32 m0, s59
    s_nop 0
    buffer_load_dwordx4 v6, s[8:11], s46 offen lds
    s_add_u32 s59, s64, 61440
    s_mov_b32 m0, s59
    s_nop 0
    buffer_load_dwordx4 v20, s[12:15], s47 offen lds
    s_add_u32 s59, s65, 61440
    s_mov_b32 m0, s59
    s_nop 0
    buffer_load_dwordx4 v21, s[12:15], s47 offen lds
    s_add_u32 s59, s66, 61440
    s_mov_b32 m0, s59
    s_nop 0
    buffer_load_dwordx4 v22, s[12:15], s47 offen lds
    s_add_u32 s59, s67, 61440
    s_mov_b32 m0, s59
    s_nop 0
    buffer_load_dwordx4 v23, s[12:15], s47 offen lds
    s_waitcnt vmcnt(6)
    s_barrier
    ds_read_b128 v[40:43], v28 offset:0
    ds_read_b128 v[44:47], v28 offset:2048
    ds_read_b128 v[48:51], v28 offset:4096
    ds_read_b128 v[52:55], v28 offset:6144
    ds_read_b64_tr_b16 v[56:57], v30 offset:0
    ds_read_b64_tr_b16 v[58:59], v30 offset:1792
    ds_read_b64_tr_b16 v[60:61], v31 offset:32
    ds_read_b64_tr_b16 v[62:63], v31 offset:1824
    ds_read_b64_tr_b16 v[64:65], v30 offset:64
    ds_read_b64_tr_b16 v[66:67], v30 offset:1856
    ds_read_b64_tr_b16 v[68:69], v31 offset:96
    ds_read_b64_tr_b16 v[70:71], v31 offset:1888
    ds_read_b64_tr_b16 v[72:73], v30 offset:128
    ds_read_b64_tr_b16 v[74:75], v30 offset:1920
    ds_read_b64_tr_b16 v[76:77], v31 offset:160
    ds_read_b64_tr_b16 v[78:79], v31 offset:1952
    ds_read_b64_tr_b16 v[80:81], v30 offset:192
    ds_read_b64_tr_b16 v[82:83], v30 offset:1984
    s_mov_b32 s46, 256
    s_mov_b32 s47, 458752
    s_add_u32 s59, s58, 90112
    s_mov_b32 m0, s59
    s_nop 0
    buffer_load_dwordx4 v5, s[8:11], s46 offen lds
    s_add_u32 s59, s58, 91136
    s_mov_b32 m0, s59
    s_nop 0
    buffer_load_dwordx4 v6, s[8:11], s46 offen lds
    s_add_u32 s59, s64, 106496
    s_mov_b32 m0, s59
    s_nop 0
    buffer_load_dwordx4 v20, s[12:15], s47 offen lds
    s_add_u32 s59, s65, 106496
    s_mov_b32 m0, s59
    s_nop 0
    buffer_load_dwordx4 v21, s[12:15], s47 offen lds
    s_add_u32 s59, s66, 106496
    s_mov_b32 m0, s59
    s_nop 0
    buffer_load_dwordx4 v22, s[12:15], s47 offen lds
    s_add_u32 s59, s67, 106496
    s_mov_b32 m0, s59
    s_nop 0
    buffer_load_dwordx4 v23, s[12:15], s47 offen lds
    s_waitcnt lgkmcnt(12)
    v_mfma_f32_16x16x32_bf16 a[0:3], v[56:59], v[40:43], a[0:3]
    v_mfma_f32_16x16x32_bf16 a[4:7], v[56:59], v[44:47], a[4:7]
    v_mfma_f32_16x16x32_bf16 a[8:11], v[56:59], v[48:51], a[8:11]
    v_mfma_f32_16x16x32_bf16 a[12:15], v[56:59], v[52:55], a[12:15]
    s_waitcnt lgkmcnt(10)
    v_mfma_f32_16x16x32_bf16 a[16:19], v[60:63], v[40:43], a[16:19]
    v_mfma_f32_16x16x32_bf16 a[20:23], v[60:63], v[44:47], a[20:23]
    v_mfma_f32_16x16x32_bf16 a[24:27], v[60:63], v[48:51], a[24:27]
    v_mfma_f32_16x16x32_bf16 a[28:31], v[60:63], v[52:55], a[28:31]
    s_waitcnt lgkmcnt(8)
    v_mfma_f32_16x16x32_bf16 a[32:35], v[64:67], v[40:43], a[32:35]
    v_mfma_f32_16x16x32_bf16 a[36:39], v[64:67], v[44:47], a[36:39]
    v_mfma_f32_16x16x32_bf16 a[40:43], v[64:67], v[48:51], a[40:43]
    v_mfma_f32_16x16x32_bf16 a[44:47], v[64:67], v[52:55], a[44:47]
    s_waitcnt lgkmcnt(6)
    v_mfma_f32_16x16x32_bf16 a[48:51], v[68:71], v[40:43], a[48:51]
    v_mfma_f32_16x16x32_bf16 a[52:55], v[68:71], v[44:47], a[52:55]
    v_mfma_f32_16x16x32_bf16 a[56:59], v[68:71], v[48:51], a[56:59]
    v_mfma_f32_16x16x32_bf16 a[60:63], v[68:71], v[52:55], a[60:63]
    s_waitcnt lgkmcnt(4)
    v_mfma_f32_16x16x32_bf16 a[64:67], v[72:75], v[40:43], a[64:67]
    v_mfma_f32_16x16x32_bf16 a[68:71], v[72:75], v[44:47], a[68:71]
    v_mfma_f32_16x16x32_bf16 a[72:75], v[72:75], v[48:51], a[72:75]
    v_mfma_f32_16x16x32_bf16 a[76:79], v[72:75], v[52:55], a[76:79]
    s_waitcnt lgkmcnt(2)
    v_mfma_f32_16x16x32_bf16 a[80:83], v[76:79], v[40:43], a[80:83]
    v_mfma_f32_16x16x32_bf16 a[84:87], v[76:79], v[44:47], a[84:87]
    v_mfma_f32_16x16x32_bf16 a[88:91], v[76:79], v[48:51], a[88:91]
    v_mfma_f32_16x16x32_bf16 a[92:95], v[76:79], v[52:55], a[92:95]
    s_waitcnt lgkmcnt(0)
    v_mfma_f32_16x16x32_bf16 a[96:99], v[80:83], v[40:43], a[96:99]
    v_mfma_f32_16x16x32_bf16 a[100:103], v[80:83], v[44:47], a[100:103]
    v_mfma_f32_16x16x32_bf16 a[104:107], v[80:83], v[48:51], a[104:107]
    v_mfma_f32_16x16x32_bf16 a[108:111], v[80:83], v[52:55], a[108:111]
    s_waitcnt vmcnt(6)
    s_barrier
    ds_read_b128 v[40:43], v28 offset:45056
    ds_read_b128 v[44:47], v28 offset:47104
    ds_read_b128 v[48:51], v28 offset:49152
    ds_read_b128 v[52:55], v28 offset:51200
    ds_read_b64_tr_b16 v[56:57], v30 offset:45056
    ds_read_b64_tr_b16 v[58:59], v30 offset:46848
    ds_read_b64_tr_b16 v[60:61], v31 offset:45088
    ds_read_b64_tr_b16 v[62:63], v31 offset:46880
    ds_read_b64_tr_b16 v[64:65], v30 offset:45120
    ds_read_b64_tr_b16 v[66:67], v30 offset:46912
    ds_read_b64_tr_b16 v[68:69], v31 offset:45152
    ds_read_b64_tr_b16 v[70:71], v31 offset:46944
    ds_read_b64_tr_b16 v[72:73], v30 offset:45184
    ds_read_b64_tr_b16 v[74:75], v30 offset:46976
    ds_read_b64_tr_b16 v[76:77], v31 offset:45216
    ds_read_b64_tr_b16 v[78:79], v31 offset:47008
    ds_read_b64_tr_b16 v[80:81], v30 offset:45248
    ds_read_b64_tr_b16 v[82:83], v30 offset:47040
    s_mov_b32 s46, 384
    s_mov_b32 s47, 688128
    s_add_u32 s59, s58, 0
    s_mov_b32 m0, s59
    s_nop 0
    buffer_load_dwordx4 v5, s[8:11], s46 offen lds
    s_add_u32 s59, s58, 1024
    s_mov_b32 m0, s59
    s_nop 0
    buffer_load_dwordx4 v6, s[8:11], s46 offen lds
    s_add_u32 s59, s64, 16384
    s_mov_b32 m0, s59
    s_nop 0
    buffer_load_dwordx4 v20, s[12:15], s47 offen lds
    s_add_u32 s59, s65, 16384
    s_mov_b32 m0, s59
    s_nop 0
    buffer_load_dwordx4 v21, s[12:15], s47 offen lds
    s_add_u32 s59, s66, 16384
    s_mov_b32 m0, s59
    s_nop 0
    buffer_load_dwordx4 v22, s[12:15], s47 offen lds
    s_add_u32 s59, s67, 16384
    s_mov_b32 m0, s59
    s_nop 0
    buffer_load_dwordx4 v23, s[12:15], s47 offen lds
    s_waitcnt lgkmcnt(12)
    v_mfma_f32_16x16x32_bf16 a[0:3], v[56:59], v[40:43], a[0:3]
    v_mfma_f32_16x16x32_bf16 a[4:7], v[56:59], v[44:47], a[4:7]
    v_mfma_f32_16x16x32_bf16 a[8:11], v[56:59], v[48:51], a[8:11]
    v_mfma_f32_16x16x32_bf16 a[12:15], v[56:59], v[52:55], a[12:15]
    s_waitcnt lgkmcnt(10)
    v_mfma_f32_16x16x32_bf16 a[16:19], v[60:63], v[40:43], a[16:19]
    v_mfma_f32_16x16x32_bf16 a[20:23], v[60:63], v[44:47], a[20:23]
    v_mfma_f32_16x16x32_bf16 a[24:27], v[60:63], v[48:51], a[24:27]
    v_mfma_f32_16x16x32_bf16 a[28:31], v[60:63], v[52:55], a[28:31]
    s_waitcnt lgkmcnt(8)
    v_mfma_f32_16x16x32_bf16 a[32:35], v[64:67], v[40:43], a[32:35]
    v_mfma_f32_16x16x32_bf16 a[36:39], v[64:67], v[44:47], a[36:39]
    v_mfma_f32_16x16x32_bf16 a[40:43], v[64:67], v[48:51], a[40:43]
    v_mfma_f32_16x16x32_bf16 a[44:47], v[64:67], v[52:55], a[44:47]
    s_waitcnt lgkmcnt(6)
    v_mfma_f32_16x16x32_bf16 a[48:51], v[68:71], v[40:43], a[48:51]
    v_mfma_f32_16x16x32_bf16 a[52:55], v[68:71], v[44:47], a[52:55]
    v_mfma_f32_16x16x32_bf16 a[56:59], v[68:71], v[48:51], a[56:59]
    v_mfma_f32_16x16x32_bf16 a[60:63], v[68:71], v[52:55], a[60:63]
    s_waitcnt lgkmcnt(4)
    v_mfma_f32_16x16x32_bf16 a[64:67], v[72:75], v[40:43], a[64:67]
    v_mfma_f32_16x16x32_bf16 a[68:71], v[72:75], v[44:47], a[68:71]
    v_mfma_f32_16x16x32_bf16 a[72:75], v[72:75], v[48:51], a[72:75]
    v_mfma_f32_16x16x32_bf16 a[76:79], v[72:75], v[52:55], a[76:79]
    s_waitcnt lgkmcnt(2)
    v_mfma_f32_16x16x32_bf16 a[80:83], v[76:79], v[40:43], a[80:83]
    v_mfma_f32_16x16x32_bf16 a[84:87], v[76:79], v[44:47], a[84:87]
    v_mfma_f32_16x16x32_bf16 a[88:91], v[76:79], v[48:51], a[88:91]
    v_mfma_f32_16x16x32_bf16 a[92:95], v[76:79], v[52:55], a[92:95]
    s_waitcnt lgkmcnt(0)
    v_mfma_f32_16x16x32_bf16 a[96:99], v[80:83], v[40:43], a[96:99]
    v_mfma_f32_16x16x32_bf16 a[100:103], v[80:83], v[44:47], a[100:103]
    v_mfma_f32_16x16x32_bf16 a[104:107], v[80:83], v[48:51], a[104:107]
    v_mfma_f32_16x16x32_bf16 a[108:111], v[80:83], v[52:55], a[108:111]
    s_waitcnt vmcnt(6)
    s_barrier
    ds_read_b128 v[40:43], v29 offset:0
    ds_read_b128 v[44:47], v29 offset:2048
    ds_read_b128 v[48:51], v29 offset:4096
    ds_read_b128 v[52:55], v29 offset:6144
    ds_read_b64_tr_b16 v[56:57], v32 offset:0
    ds_read_b64_tr_b16 v[58:59], v32 offset:1792
    ds_read_b64_tr_b16 v[60:61], v33 offset:32
    ds_read_b64_tr_b16 v[62:63], v33 offset:1824
    ds_read_b64_tr_b16 v[64:65], v32 offset:64
    ds_read_b64_tr_b16 v[66:67], v32 offset:1856
    ds_read_b64_tr_b16 v[68:69], v33 offset:96
    ds_read_b64_tr_b16 v[70:71], v33 offset:1888
    ds_read_b64_tr_b16 v[72:73], v32 offset:128
    ds_read_b64_tr_b16 v[74:75], v32 offset:1920
    ds_read_b64_tr_b16 v[76:77], v33 offset:160
    ds_read_b64_tr_b16 v[78:79], v33 offset:1952
    ds_read_b64_tr_b16 v[80:81], v32 offset:192
    ds_read_b64_tr_b16 v[82:83], v32 offset:1984
    s_mov_b32 s46, 512
    s_mov_b32 s47, 917504
    s_add_u32 s59, s58, 45056
    s_mov_b32 m0, s59
    s_nop 0
    buffer_load_dwordx4 v5, s[8:11], s46 offen lds
    s_add_u32 s59, s58, 46080
    s_mov_b32 m0, s59
    s_nop 0
    buffer_load_dwordx4 v6, s[8:11], s46 offen lds
    s_add_u32 s59, s64, 61440
    s_mov_b32 m0, s59
    s_nop 0
    buffer_load_dwordx4 v20, s[12:15], s47 offen lds
    s_add_u32 s59, s65, 61440
    s_mov_b32 m0, s59
    s_nop 0
    buffer_load_dwordx4 v21, s[12:15], s47 offen lds
    s_add_u32 s59, s66, 61440
    s_mov_b32 m0, s59
    s_nop 0
    buffer_load_dwordx4 v22, s[12:15], s47 offen lds
    s_add_u32 s59, s67, 61440
    s_mov_b32 m0, s59
    s_nop 0
    buffer_load_dwordx4 v23, s[12:15], s47 offen lds
    s_waitcnt lgkmcnt(12)
    v_mfma_f32_16x16x32_bf16 a[0:3], v[56:59], v[40:43], a[0:3]
    v_mfma_f32_16x16x32_bf16 a[4:7], v[56:59], v[44:47], a[4:7]
    v_mfma_f32_16x16x32_bf16 a[8:11], v[56:59], v[48:51], a[8:11]
    v_mfma_f32_16x16x32_bf16 a[12:15], v[56:59], v[52:55], a[12:15]
    s_waitcnt lgkmcnt(10)
    v_mfma_f32_16x16x32_bf16 a[16:19], v[60:63], v[40:43], a[16:19]
    v_mfma_f32_16x16x32_bf16 a[20:23], v[60:63], v[44:47], a[20:23]
    v_mfma_f32_16x16x32_bf16 a[24:27], v[60:63], v[48:51], a[24:27]
    v_mfma_f32_16x16x32_bf16 a[28:31], v[60:63], v[52:55], a[28:31]
    s_waitcnt lgkmcnt(8)
    v_mfma_f32_16x16x32_bf16 a[32:35], v[64:67], v[40:43], a[32:35]
    v_mfma_f32_16x16x32_bf16 a[36:39], v[64:67], v[44:47], a[36:39]
    v_mfma_f32_16x16x32_bf16 a[40:43], v[64:67], v[48:51], a[40:43]
    v_mfma_f32_16x16x32_bf16 a[44:47], v[64:67], v[52:55], a[44:47]
    s_waitcnt lgkmcnt(6)
    v_mfma_f32_16x16x32_bf16 a[48:51], v[68:71], v[40:43], a[48:51]
    v_mfma_f32_16x16x32_bf16 a[52:55], v[68:71], v[44:47], a[52:55]
    v_mfma_f32_16x16x32_bf16 a[56:59], v[68:71], v[48:51], a[56:59]
    v_mfma_f32_16x16x32_bf16 a[60:63], v[68:71], v[52:55], a[60:63]
    s_waitcnt lgkmcnt(4)
    v_mfma_f32_16x16x32_bf16 a[64:67], v[72:75], v[40:43], a[64:67]
    v_mfma_f32_16x16x32_bf16 a[68:71], v[72:75], v[44:47], a[68:71]
    v_mfma_f32_16x16x32_bf16 a[72:75], v[72:75], v[48:51], a[72:75]
    v_mfma_f32_16x16x32_bf16 a[76:79], v[72:75], v[52:55], a[76:79]
    s_waitcnt lgkmcnt(2)
    v_mfma_f32_16x16x32_bf16 a[80:83], v[76:79], v[40:43], a[80:83]
    v_mfma_f32_16x16x32_bf16 a[84:87], v[76:79], v[44:47], a[84:87]
    v_mfma_f32_16x16x32_bf16 a[88:91], v[76:79], v[48:51], a[88:91]
    v_mfma_f32_16x16x32_bf16 a[92:95], v[76:79], v[52:55], a[92:95]
    s_waitcnt lgkmcnt(0)
    v_mfma_f32_16x16x32_bf16 a[96:99], v[80:83], v[40:43], a[96:99]
    v_mfma_f32_16x16x32_bf16 a[100:103], v[80:83], v[44:47], a[100:103]
    v_mfma_f32_16x16x32_bf16 a[104:107], v[80:83], v[48:51], a[104:107]
    v_mfma_f32_16x16x32_bf16 a[108:111], v[80:83], v[52:55], a[108:111]
    s_waitcnt vmcnt(6)
    s_barrier
    ds_read_b128 v[40:43], v28 offset:0
    ds_read_b128 v[44:47], v28 offset:2048
    ds_read_b128 v[48:51], v28 offset:4096
    ds_read_b128 v[52:55], v28 offset:6144
    ds_read_b64_tr_b16 v[56:57], v30 offset:0
    ds_read_b64_tr_b16 v[58:59], v30 offset:1792
    ds_read_b64_tr_b16 v[60:61], v31 offset:32
    ds_read_b64_tr_b16 v[62:63], v31 offset:1824
    ds_read_b64_tr_b16 v[64:65], v30 offset:64
    ds_read_b64_tr_b16 v[66:67], v30 offset:1856
    ds_read_b64_tr_b16 v[68:69], v31 offset:96
    ds_read_b64_tr_b16 v[70:71], v31 offset:1888
    ds_read_b64_tr_b16 v[72:73], v30 offset:128
    ds_read_b64_tr_b16 v[74:75], v30 offset:1920
    ds_read_b64_tr_b16 v[76:77], v31 offset:160
    ds_read_b64_tr_b16 v[78:79], v31 offset:1952
    ds_read_b64_tr_b16 v[80:81], v30 offset:192
    ds_read_b64_tr_b16 v[82:83], v30 offset:1984
    s_mov_b32 s46, 640
    s_mov_b32 s47, 1146880
    s_add_u32 s59, s58, 90112
    s_mov_b32 m0, s59
    s_nop 0
    buffer_load_dwordx4 v5, s[8:11], s46 offen lds
    s_add_u32 s59, s58, 91136
    s_mov_b32 m0, s59
    s_nop 0
    buffer_load_dwordx4 v6, s[8:11], s46 offen lds
    s_add_u32 s59, s64, 106496
    s_mov_b32 m0, s59
    s_nop 0
    buffer_load_dwordx4 v20, s[12:15], s47 offen lds
    s_add_u32 s59, s65, 106496
    s_mov_b32 m0, s59
    s_nop 0
    buffer_load_dwordx4 v21, s[12:15], s47 offen lds
    s_add_u32 s59, s66, 106496
    s_mov_b32 m0, s59
    s_nop 0
    buffer_load_dwordx4 v22, s[12:15], s47 offen lds
    s_add_u32 s59, s67, 106496
    s_mov_b32 m0, s59
    s_nop 0
    buffer_load_dwordx4 v23, s[12:15], s47 offen lds
    s_waitcnt lgkmcnt(12)
    v_mfma_f32_16x16x32_bf16 a[0:3], v[56:59], v[40:43], a[0:3]
    v_mfma_f32_16x16x32_bf16 a[4:7], v[56:59], v[44:47], a[4:7]
    v_mfma_f32_16x16x32_bf16 a[8:11], v[56:59], v[48:51], a[8:11]
    v_mfma_f32_16x16x32_bf16 a[12:15], v[56:59], v[52:55], a[12:15]
    s_waitcnt lgkmcnt(10)
    v_mfma_f32_16x16x32_bf16 a[16:19], v[60:63], v[40:43], a[16:19]
    v_mfma_f32_16x16x32_bf16 a[20:23], v[60:63], v[44:47], a[20:23]
    v_mfma_f32_16x16x32_bf16 a[24:27], v[60:63], v[48:51], a[24:27]
    v_mfma_f32_16x16x32_bf16 a[28:31], v[60:63], v[52:55], a[28:31]
    s_waitcnt lgkmcnt(8)
    v_mfma_f32_16x16x32_bf16 a[32:35], v[64:67], v[40:43], a[32:35]
    v_mfma_f32_16x16x32_bf16 a[36:39], v[64:67], v[44:47], a[36:39]
    v_mfma_f32_16x16x32_bf16 a[40:43], v[64:67], v[48:51], a[40:43]
    v_mfma_f32_16x16x32_bf16 a[44:47], v[64:67], v[52:55], a[44:47]
    s_waitcnt lgkmcnt(6)
    v_mfma_f32_16x16x32_bf16 a[48:51], v[68:71], v[40:43], a[48:51]
    v_mfma_f32_16x16x32_bf16 a[52:55], v[68:71], v[44:47], a[52:55]
    v_mfma_f32_16x16x32_bf16 a[56:59], v[68:71], v[48:51], a[56:59]
    v_mfma_f32_16x16x32_bf16 a[60:63], v[68:71], v[52:55], a[60:63]
    s_waitcnt lgkmcnt(4)
    v_mfma_f32_16x16x32_bf16 a[64:67], v[72:75], v[40:43], a[64:67]
    v_mfma_f32_16x16x32_bf16 a[68:71], v[72:75], v[44:47], a[68:71]
    v_mfma_f32_16x16x32_bf16 a[72:75], v[72:75], v[48:51], a[72:75]
    v_mfma_f32_16x16x32_bf16 a[76:79], v[72:75], v[52:55], a[76:79]
    s_waitcnt lgkmcnt(2)
    v_mfma_f32_16x16x32_bf16 a[80:83], v[76:79], v[40:43], a[80:83]
    v_mfma_f32_16x16x32_bf16 a[84:87], v[76:79], v[44:47], a[84:87]
    v_mfma_f32_16x16x32_bf16 a[88:91], v[76:79], v[48:51], a[88:91]
    v_mfma_f32_16x16x32_bf16 a[92:95], v[76:79], v[52:55], a[92:95]
    s_waitcnt lgkmcnt(0)
    v_mfma_f32_16x16x32_bf16 a[96:99], v[80:83], v[40:43], a[96:99]
    v_mfma_f32_16x16x32_bf16 a[100:103], v[80:83], v[44:47], a[100:103]
    v_mfma_f32_16x16x32_bf16 a[104:107], v[80:83], v[48:51], a[104:107]
    v_mfma_f32_16x16x32_bf16 a[108:111], v[80:83], v[52:55], a[108:111]
    s_waitcnt vmcnt(6)
    s_barrier
    ds_read_b128 v[40:43], v28 offset:45056
    ds_read_b128 v[44:47], v28 offset:47104
    ds_read_b128 v[48:51], v28 offset:49152
    ds_read_b128 v[52:55], v28 offset:51200
    ds_read_b64_tr_b16 v[56:57], v30 offset:45056
    ds_read_b64_tr_b16 v[58:59], v30 offset:46848
    ds_read_b64_tr_b16 v[60:61], v31 offset:45088
    ds_read_b64_tr_b16 v[62:63], v31 offset:46880
    ds_read_b64_tr_b16 v[64:65], v30 offset:45120
    ds_read_b64_tr_b16 v[66:67], v30 offset:46912
    ds_read_b64_tr_b16 v[68:69], v31 offset:45152
    ds_read_b64_tr_b16 v[70:71], v31 offset:46944
    ds_read_b64_tr_b16 v[72:73], v30 offset:45184
    ds_read_b64_tr_b16 v[74:75], v30 offset:46976
    ds_read_b64_tr_b16 v[76:77], v31 offset:45216
    ds_read_b64_tr_b16 v[78:79], v31 offset:47008
    ds_read_b64_tr_b16 v[80:81], v30 offset:45248
    ds_read_b64_tr_b16 v[82:83], v30 offset:47040
    s_mov_b32 s46, 768
    s_mov_b32 s47, 1376256
    s_add_u32 s59, s58, 0
    s_mov_b32 m0, s59
    s_nop 0
    buffer_load_dwordx4 v5, s[8:11], s46 offen lds
    s_add_u32 s59, s58, 1024
    s_mov_b32 m0, s59
    s_nop 0
    buffer_load_dwordx4 v6, s[8:11], s46 offen lds
    s_add_u32 s59, s64, 16384
    s_mov_b32 m0, s59
    s_nop 0
    buffer_load_dwordx4 v20, s[12:15], s47 offen lds
    s_add_u32 s59, s65, 16384
    s_mov_b32 m0, s59
    s_nop 0
    buffer_load_dwordx4 v21, s[12:15], s47 offen lds
    s_add_u32 s59, s66, 16384
    s_mov_b32 m0, s59
    s_nop 0
    buffer_load_dwordx4 v22, s[12:15], s47 offen lds
    s_add_u32 s59, s67, 16384
    s_mov_b32 m0, s59
    s_nop 0
    buffer_load_dwordx4 v23, s[12:15], s47 offen lds
    s_waitcnt lgkmcnt(12)
    v_mfma_f32_16x16x32_bf16 a[0:3], v[56:59], v[40:43], a[0:3]
    v_mfma_f32_16x16x32_bf16 a[4:7], v[56:59], v[44:47], a[4:7]
    v_mfma_f32_16x16x32_bf16 a[8:11], v[56:59], v[48:51], a[8:11]
    v_mfma_f32_16x16x32_bf16 a[12:15], v[56:59], v[52:55], a[12:15]
    s_waitcnt lgkmcnt(10)
    v_mfma_f32_16x16x32_bf16 a[16:19], v[60:63], v[40:43], a[16:19]
    v_mfma_f32_16x16x32_bf16 a[20:23], v[60:63], v[44:47], a[20:23]
    v_mfma_f32_16x16x32_bf16 a[24:27], v[60:63], v[48:51], a[24:27]
    v_mfma_f32_16x16x32_bf16 a[28:31], v[60:63], v[52:55], a[28:31]
    s_waitcnt lgkmcnt(8)
    v_mfma_f32_16x16x32_bf16 a[32:35], v[64:67], v[40:43], a[32:35]
    v_mfma_f32_16x16x32_bf16 a[36:39], v[64:67], v[44:47], a[36:39]
    v_mfma_f32_16x16x32_bf16 a[40:43], v[64:67], v[48:51], a[40:43]
    v_mfma_f32_16x16x32_bf16 a[44:47], v[64:67], v[52:55], a[44:47]
    s_waitcnt lgkmcnt(6)
    v_mfma_f32_16x16x32_bf16 a[48:51], v[68:71], v[40:43], a[48:51]
    v_mfma_f32_16x16x32_bf16 a[52:55], v[68:71], v[44:47], a[52:55]
    v_mfma_f32_16x16x32_bf16 a[56:59], v[68:71], v[48:51], a[56:59]
    v_mfma_f32_16x16x32_bf16 a[60:63], v[68:71], v[52:55], a[60:63]
    s_waitcnt lgkmcnt(4)
    v_mfma_f32_16x16x32_bf16 a[64:67], v[72:75], v[40:43], a[64:67]
    v_mfma_f32_16x16x32_bf16 a[68:71], v[72:75], v[44:47], a[68:71]
    v_mfma_f32_16x16x32_bf16 a[72:75], v[72:75], v[48:51], a[72:75]
    v_mfma_f32_16x16x32_bf16 a[76:79], v[72:75], v[52:55], a[76:79]
    s_waitcnt lgkmcnt(2)
    v_mfma_f32_16x16x32_bf16 a[80:83], v[76:79], v[40:43], a[80:83]
    v_mfma_f32_16x16x32_bf16 a[84:87], v[76:79], v[44:47], a[84:87]
    v_mfma_f32_16x16x32_bf16 a[88:91], v[76:79], v[48:51], a[88:91]
    v_mfma_f32_16x16x32_bf16 a[92:95], v[76:79], v[52:55], a[92:95]
    s_waitcnt lgkmcnt(0)
    v_mfma_f32_16x16x32_bf16 a[96:99], v[80:83], v[40:43], a[96:99]
    v_mfma_f32_16x16x32_bf16 a[100:103], v[80:83], v[44:47], a[100:103]
    v_mfma_f32_16x16x32_bf16 a[104:107], v[80:83], v[48:51], a[104:107]
    v_mfma_f32_16x16x32_bf16 a[108:111], v[80:83], v[52:55], a[108:111]
    s_waitcnt vmcnt(6)
    s_barrier
    ds_read_b128 v[40:43], v29 offset:0
    ds_read_b128 v[44:47], v29 offset:2048
    ds_read_b128 v[48:51], v29 offset:4096
    ds_read_b128 v[52:55], v29 offset:6144
    ds_read_b64_tr_b16 v[56:57], v32 offset:0
    ds_read_b64_tr_b16 v[58:59], v32 offset:1792
    ds_read_b64_tr_b16 v[60:61], v33 offset:32
    ds_read_b64_tr_b16 v[62:63], v33 offset:1824
    ds_read_b64_tr_b16 v[64:65], v32 offset:64
    ds_read_b64_tr_b16 v[66:67], v32 offset:1856
    ds_read_b64_tr_b16 v[68:69], v33 offset:96
    ds_read_b64_tr_b16 v[70:71], v33 offset:1888
    ds_read_b64_tr_b16 v[72:73], v32 offset:128
    ds_read_b64_tr_b16 v[74:75], v32 offset:1920
    ds_read_b64_tr_b16 v[76:77], v33 offset:160
    ds_read_b64_tr_b16 v[78:79], v33 offset:1952
    ds_read_b64_tr_b16 v[80:81], v32 offset:192
    ds_read_b64_tr_b16 v[82:83], v32 offset:1984
    s_mov_b32 s46, 896
    s_mov_b32 s47, 1605632
    s_add_u32 s59, s58, 45056
    s_mov_b32 m0, s59
    s_nop 0
    buffer_load_dwordx4 v5, s[8:11], s46 offen lds
    s_add_u32 s59, s58, 46080
    s_mov_b32 m0, s59
    s_nop 0
    buffer_load_dwordx4 v6, s[8:11], s46 offen lds
    s_add_u32 s59, s64, 61440
    s_mov_b32 m0, s59
    s_nop 0
    buffer_load_dwordx4 v20, s[12:15], s47 offen lds
    s_add_u32 s59, s65, 61440
    s_mov_b32 m0, s59
    s_nop 0
    buffer_load_dwordx4 v21, s[12:15], s47 offen lds
    s_add_u32 s59, s66, 61440
    s_mov_b32 m0, s59
    s_nop 0
    buffer_load_dwordx4 v22, s[12:15], s47 offen lds
    s_add_u32 s59, s67, 61440
    s_mov_b32 m0, s59
    s_nop 0
    buffer_load_dwordx4 v23, s[12:15], s47 offen lds
    s_waitcnt lgkmcnt(12)
    v_mfma_f32_16x16x32_bf16 a[0:3], v[56:59], v[40:43], a[0:3]
    v_mfma_f32_16x16x32_bf16 a[4:7], v[56:59], v[44:47], a[4:7]
    v_mfma_f32_16x16x32_bf16 a[8:11], v[56:59], v[48:51], a[8:11]
    v_mfma_f32_16x16x32_bf16 a[12:15], v[56:59], v[52:55], a[12:15]
    s_waitcnt lgkmcnt(10)
    v_mfma_f32_16x16x32_bf16 a[16:19], v[60:63], v[40:43], a[16:19]
    v_mfma_f32_16x16x32_bf16 a[20:23], v[60:63], v[44:47], a[20:23]
    v_mfma_f32_16x16x32_bf16 a[24:27], v[60:63], v[48:51], a[24:27]
    v_mfma_f32_16x16x32_bf16 a[28:31], v[60:63], v[52:55], a[28:31]
    s_waitcnt lgkmcnt(8)
    v_mfma_f32_16x16x32_bf16 a[32:35], v[64:67], v[40:43], a[32:35]
    v_mfma_f32_16x16x32_bf16 a[36:39], v[64:67], v[44:47], a[36:39]
    v_mfma_f32_16x16x32_bf16 a[40:43], v[64:67], v[48:51], a[40:43]
    v_mfma_f32_16x16x32_bf16 a[44:47], v[64:67], v[52:55], a[44:47]
    s_waitcnt lgkmcnt(6)
    v_mfma_f32_16x16x32_bf16 a[48:51], v[68:71], v[40:43], a[48:51]
    v_mfma_f32_16x16x32_bf16 a[52:55], v[68:71], v[44:47], a[52:55]
    v_mfma_f32_16x16x32_bf16 a[56:59], v[68:71], v[48:51], a[56:59]
    v_mfma_f32_16x16x32_bf16 a[60:63], v[68:71], v[52:55], a[60:63]
    s_waitcnt lgkmcnt(4)
    v_mfma_f32_16x16x32_bf16 a[64:67], v[72:75], v[40:43], a[64:67]
    v_mfma_f32_16x16x32_bf16 a[68:71], v[72:75], v[44:47], a[68:71]
    v_mfma_f32_16x16x32_bf16 a[72:75], v[72:75], v[48:51], a[72:75]
    v_mfma_f32_16x16x32_bf16 a[76:79], v[72:75], v[52:55], a[76:79]
    s_waitcnt lgkmcnt(2)
    v_mfma_f32_16x16x32_bf16 a[80:83], v[76:79], v[40:43], a[80:83]
    v_mfma_f32_16x16x32_bf16 a[84:87], v[76:79], v[44:47], a[84:87]
    v_mfma_f32_16x16x32_bf16 a[88:91], v[76:79], v[48:51], a[88:91]
    v_mfma_f32_16x16x32_bf16 a[92:95], v[76:79], v[52:55], a[92:95]
    s_waitcnt lgkmcnt(0)
    v_mfma_f32_16x16x32_bf16 a[96:99], v[80:83], v[40:43], a[96:99]
    v_mfma_f32_16x16x32_bf16 a[100:103], v[80:83], v[44:47], a[100:103]
    v_mfma_f32_16x16x32_bf16 a[104:107], v[80:83], v[48:51], a[104:107]
    v_mfma_f32_16x16x32_bf16 a[108:111], v[80:83], v[52:55], a[108:111]
    s_waitcnt vmcnt(6)
    s_barrier
    ds_read_b128 v[40:43], v28 offset:0
    ds_read_b128 v[44:47], v28 offset:2048
    ds_read_b128 v[48:51], v28 offset:4096
    ds_read_b128 v[52:55], v28 offset:6144
    ds_read_b64_tr_b16 v[56:57], v30 offset:0
    ds_read_b64_tr_b16 v[58:59], v30 offset:1792
    ds_read_b64_tr_b16 v[60:61], v31 offset:32
    ds_read_b64_tr_b16 v[62:63], v31 offset:1824
    ds_read_b64_tr_b16 v[64:65], v30 offset:64
    ds_read_b64_tr_b16 v[66:67], v30 offset:1856
    ds_read_b64_tr_b16 v[68:69], v31 offset:96
    ds_read_b64_tr_b16 v[70:71], v31 offset:1888
    ds_read_b64_tr_b16 v[72:73], v30 offset:128
    ds_read_b64_tr_b16 v[74:75], v30 offset:1920
    ds_read_b64_tr_b16 v[76:77], v31 offset:160
    ds_read_b64_tr_b16 v[78:79], v31 offset:1952
    ds_read_b64_tr_b16 v[80:81], v30 offset:192
    ds_read_b64_tr_b16 v[82:83], v30 offset:1984
    s_waitcnt lgkmcnt(12)
    v_mfma_f32_16x16x32_bf16 a[0:3], v[56:59], v[40:43], a[0:3]
    v_mfma_f32_16x16x32_bf16 a[4:7], v[56:59], v[44:47], a[4:7]
    v_mfma_f32_16x16x32_bf16 a[8:11], v[56:59], v[48:51], a[8:11]
    v_mfma_f32_16x16x32_bf16 a[12:15], v[56:59], v[52:55], a[12:15]
    s_waitcnt lgkmcnt(10)
    v_mfma_f32_16x16x32_bf16 a[16:19], v[60:63], v[40:43], a[16:19]
    v_mfma_f32_16x16x32_bf16 a[20:23], v[60:63], v[44:47], a[20:23]
    v_mfma_f32_16x16x32_bf16 a[24:27], v[60:63], v[48:51], a[24:27]
    v_mfma_f32_16x16x32_bf16 a[28:31], v[60:63], v[52:55], a[28:31]
    s_waitcnt lgkmcnt(8)
    v_mfma_f32_16x16x32_bf16 a[32:35], v[64:67], v[40:43], a[32:35]
    v_mfma_f32_16x16x32_bf16 a[36:39], v[64:67], v[44:47], a[36:39]
    v_mfma_f32_16x16x32_bf16 a[40:43], v[64:67], v[48:51], a[40:43]
    v_mfma_f32_16x16x32_bf16 a[44:47], v[64:67], v[52:55], a[44:47]
    s_waitcnt lgkmcnt(6)
    v_mfma_f32_16x16x32_bf16 a[48:51], v[68:71], v[40:43], a[48:51]
    v_mfma_f32_16x16x32_bf16 a[52:55], v[68:71], v[44:47], a[52:55]
    v_mfma_f32_16x16x32_bf16 a[56:59], v[68:71], v[48:51], a[56:59]
    v_mfma_f32_16x16x32_bf16 a[60:63], v[68:71], v[52:55], a[60:63]
    s_waitcnt lgkmcnt(4)
    v_mfma_f32_16x16x32_bf16 a[64:67], v[72:75], v[40:43], a[64:67]
    v_mfma_f32_16x16x32_bf16 a[68:71], v[72:75], v[44:47], a[68:71]
    v_mfma_f32_16x16x32_bf16 a[72:75], v[72:75], v[48:51], a[72:75]
    v_mfma_f32_16x16x32_bf16 a[76:79], v[72:75], v[52:55], a[76:79]
    s_waitcnt lgkmcnt(2)
    v_mfma_f32_16x16x32_bf16 a[80:83], v[76:79], v[40:43], a[80:83]
    v_mfma_f32_16x16x32_bf16 a[84:87], v[76:79], v[44:47], a[84:87]
    v_mfma_f32_16x16x32_bf16 a[88:91], v[76:79], v[48:51], a[88:91]
    v_mfma_f32_16x16x32_bf16 a[92:95], v[76:79], v[52:55], a[92:95]
    s_waitcnt lgkmcnt(0)
    v_mfma_f32_16x16x32_bf16 a[96:99], v[80:83], v[40:43], a[96:99]
    v_mfma_f32_16x16x32_bf16 a[100:103], v[80:83], v[44:47], a[100:103]
    v_mfma_f32_16x16x32_bf16 a[104:107], v[80:83], v[48:51], a[104:107]
    v_mfma_f32_16x16x32_bf16 a[108:111], v[80:83], v[52:55], a[108:111]
    s_waitcnt vmcnt(0)
    s_barrier
    ds_read_b128 v[40:43], v28 offset:45056
    ds_read_b128 v[44:47], v28 offset:47104
    ds_read_b128 v[48:51], v28 offset:49152
    ds_read_b128 v[52:55], v28 offset:51200
    ds_read_b64_tr_b16 v[56:57], v30 offset:45056
    ds_read_b64_tr_b16 v[58:59], v30 offset:46848
    ds_read_b64_tr_b16 v[60:61], v31 offset:45088
    ds_read_b64_tr_b16 v[62:63], v31 offset:46880
    ds_read_b64_tr_b16 v[64:65], v30 offset:45120
    ds_read_b64_tr_b16 v[66:67], v30 offset:46912
    ds_read_b64_tr_b16 v[68:69], v31 offset:45152
    ds_read_b64_tr_b16 v[70:71], v31 offset:46944
    ds_read_b64_tr_b16 v[72:73], v30 offset:45184
    ds_read_b64_tr_b16 v[74:75], v30 offset:46976
    ds_read_b64_tr_b16 v[76:77], v31 offset:45216
    ds_read_b64_tr_b16 v[78:79], v31 offset:47008
    ds_read_b64_tr_b16 v[80:81], v30 offset:45248
    ds_read_b64_tr_b16 v[82:83], v30 offset:47040
    s_waitcnt lgkmcnt(12)
    v_mfma_f32_16x16x32_bf16 a[0:3], v[56:59], v[40:43], a[0:3]
    v_mfma_f32_16x16x32_bf16 a[4:7], v[56:59], v[44:47], a[4:7]
    v_mfma_f32_16x16x32_bf16 a[8:11], v[56:59], v[48:51], a[8:11]
    v_mfma_f32_16x16x32_bf16 a[12:15], v[56:59], v[52:55], a[12:15]
    s_waitcnt lgkmcnt(10)
    v_mfma_f32_16x16x32_bf16 a[16:19], v[60:63], v[40:43], a[16:19]
    v_mfma_f32_16x16x32_bf16 a[20:23], v[60:63], v[44:47], a[20:23]
    v_mfma_f32_16x16x32_bf16 a[24:27], v[60:63], v[48:51], a[24:27]
    v_mfma_f32_16x16x32_bf16 a[28:31], v[60:63], v[52:55], a[28:31]
    s_waitcnt lgkmcnt(8)
    v_mfma_f32_16x16x32_bf16 a[32:35], v[64:67], v[40:43], a[32:35]
    v_mfma_f32_16x16x32_bf16 a[36:39], v[64:67], v[44:47], a[36:39]
    v_mfma_f32_16x16x32_bf16 a[40:43], v[64:67], v[48:51], a[40:43]
    v_mfma_f32_16x16x32_bf16 a[44:47], v[64:67], v[52:55], a[44:47]
    s_waitcnt lgkmcnt(6)
    v_mfma_f32_16x16x32_bf16 a[48:51], v[68:71], v[40:43], a[48:51]
    v_mfma_f32_16x16x32_bf16 a[52:55], v[68:71], v[44:47], a[52:55]
    v_mfma_f32_16x16x32_bf16 a[56:59], v[68:71], v[48:51], a[56:59]
    v_mfma_f32_16x16x32_bf16 a[60:63], v[68:71], v[52:55], a[60:63]
    s_waitcnt lgkmcnt(4)
    v_mfma_f32_16x16x32_bf16 a[64:67], v[72:75], v[40:43], a[64:67]
    v_mfma_f32_16x16x32_bf16 a[68:71], v[72:75], v[44:47], a[68:71]
    v_mfma_f32_16x16x32_bf16 a[72:75], v[72:75], v[48:51], a[72:75]
    v_mfma_f32_16x16x32_bf16 a[76:79], v[72:75], v[52:55], a[76:79]
    s_waitcnt lgkmcnt(2)
    v_mfma_f32_16x16x32_bf16 a[80:83], v[76:79], v[40:43], a[80:83]
    v_mfma_f32_16x16x32_bf16 a[84:87], v[76:79], v[44:47], a[84:87]
    v_mfma_f32_16x16x32_bf16 a[88:91], v[76:79], v[48:51], a[88:91]
    v_mfma_f32_16x16x32_bf16 a[92:95], v[76:79], v[52:55], a[92:95]
    s_waitcnt lgkmcnt(0)
    v_mfma_f32_16x16x32_bf16 a[96:99], v[80:83], v[40:43], a[96:99]
    v_mfma_f32_16x16x32_bf16 a[100:103], v[80:83], v[44:47], a[100:103]
    v_mfma_f32_16x16x32_bf16 a[104:107], v[80:83], v[48:51], a[104:107]
    v_mfma_f32_16x16x32_bf16 a[108:111], v[80:83], v[52:55], a[108:111]
    s_nop 7
    s_nop 7
    s_barrier
    v_lshlrev_b32 v34, 4, v2
    s_mul_i32 s51, s5, 14336
    v_add_u32 v35, s51, v34
    s_xor_b32 s52, s5, 4
    s_mul_i32 s51, s52, 14336
    v_add_u32 v36, s51, v34
    s_cmp_eq_u32 s61, 0
    s_cbranch_scc0 K1F_X1
    ds_write_b128 v35, a[8:11] offset:0
    ds_write_b128 v35, a[12:15] offset:1024
    ds_write_b128 v35, a[24:27] offset:2048
    ds_write_b128 v35, a[28:31] offset:3072
    ds_write_b128 v35, a[40:43] offset:4096
    ds_write_b128 v35, a[44:47] offset:5120
    ds_write_b128 v35, a[56:59] offset:6144
    ds_write_b128 v35, a[60:63] offset:7168
    ds_write_b128 v35, a[72:75] offset:8192
    ds_write_b128 v35, a[76:79] offset:9216
    ds_write_b128 v35, a[88:91] offset:10240
    ds_write_b128 v35, a[92:95] offset:11264
    ds_write_b128 v35, a[104:107] offset:12288
    ds_write_b128 v35, a[108:111] offset:13312
    s_branch K1F_X2
K1F_X1:
    ds_write_b128 v35, a[0:3] offset:0
    ds_write_b128 v35, a[4:7] offset:1024
    ds_write_b128 v35, a[16:19] offset:2048
    ds_write_b128 v35, a[20:23] offset:3072
    ds_write_b128 v35, a[32:35] offset:4096
    ds_write_b128 v35, a[36:39] offset:5120
    ds_write_b128 v35, a[48:51] offset:6144
    ds_write_b128 v35, a[52:55] offset:7168
    ds_write_b128 v35, a[64:67] offset:8192
    ds_write_b128 v35, a[68:71] offset:9216
    ds_write_b128 v35, a[80:83] offset:10240
    ds_write_b128 v35, a[84:87] offset:11264
    ds_write_b128 v35, a[96:99] offset:12288
    ds_write_b128 v35, a[100:103] offset:13312
    v_accvgpr_read_b32 v37, a8
    v_accvgpr_write_b32 a0, v37
    v_accvgpr_read_b32 v37, a9
    v_accvgpr_write_b32 a1, v37
    v_accvgpr_read_b32 v37, a10
    v_accvgpr_write_b32 a2, v37
    v_accvgpr_read_b32 v37, a11
    v_accvgpr_write_b32 a3, v37
    v_accvgpr_read_b32 v37, a12
    v_accvgpr_write_b32 a4, v37
    v_accvgpr_read_b32 v37, a13
    v_accvgpr_write_b32 a5, v37
    v_accvgpr_read_b32 v37, a14
    v_accvgpr_write_b32 a6, v37
    v_accvgpr_read_b32 v37, a15
    v_accvgpr_write_b32 a7, v37
    v_accvgpr_read_b32 v37, a24
    v_accvgpr_write_b32 a16, v37
    v_accvgpr_read_b32 v37, a25
    v_accvgpr_write_b32 a17, v37
    v_accvgpr_read_b32 v37, a26
    v_accvgpr_write_b32 a18, v37
    v_accvgpr_read_b32 v37, a27
    v_accvgpr_write_b32 a19, v37
    v_accvgpr_read_b32 v37, a28
    v_accvgpr_write_b32 a20, v37
    v_accvgpr_read_b32 v37, a29
    v_accvgpr_write_b32 a21, v37
    v_accvgpr_read_b32 v37, a30
    v_accvgpr_write_b32 a22, v37
    v_accvgpr_read_b32 v37, a31
    v_accvgpr_write_b32 a23, v37
    v_accvgpr_read_b32 v37, a40
    v_accvgpr_write_b32 a32, v37
    v_accvgpr_read_b32 v37, a41
    v_accvgpr_write_b32 a33, v37
    v_accvgpr_read_b32 v37, a42
    v_accvgpr_write_b32 a34, v37
    v_accvgpr_read_b32 v37, a43
    v_accvgpr_write_b32 a35, v37
    v_accvgpr_read_b32 v37, a44
    v_accvgpr_write_b32 a36, v37
    v_accvgpr_read_b32 v37, a45
    v_accvgpr_write_b32 a37, v37
    v_accvgpr_read_b32 v37, a46
    v_accvgpr_write_b32 a38, v37
    v_accvgpr_read_b32 v37, a47
    v_accvgpr_write_b32 a39, v37
    v_accvgpr_read_b32 v37, a56
    v_accvgpr_write_b32 a48, v37
    v_accvgpr_read_b32 v37, a57
    v_accvgpr_write_b32 a49, v37
    v_accvgpr_read_b32 v37, a58
    v_accvgpr_write_b32 a50, v37
    v_accvgpr_read_b32 v37, a59
    v_accvgpr_write_b32 a51, v37
    v_accvgpr_read_b32 v37, a60
    v_accvgpr_write_b32 a52, v37
    v_accvgpr_read_b32 v37, a61
    v_accvgpr_write_b32 a53, v37
    v_accvgpr_read_b32 v37, a62
    v_accvgpr_write_b32 a54, v37
    v_accvgpr_read_b32 v37, a63
    v_accvgpr_write_b32 a55, v37
    v_accvgpr_read_b32 v37, a72
    v_accvgpr_write_b32 a64, v37
    v_accvgpr_read_b32 v37, a73
    v_accvgpr_write_b32 a65, v37
    v_accvgpr_read_b32 v37, a74
    v_accvgpr_write_b32 a66, v37
    v_accvgpr_read_b32 v37, a75
    v_accvgpr_write_b32 a67, v37
    v_accvgpr_read_b32 v37, a76
    v_accvgpr_write_b32 a68, v37
    v_accvgpr_read_b32 v37, a77
    v_accvgpr_write_b32 a69, v37
    v_accvgpr_read_b32 v37, a78
    v_accvgpr_write_b32 a70, v37
    v_accvgpr_read_b32 v37, a79
    v_accvgpr_write_b32 a71, v37
    v_accvgpr_read_b32 v37, a88
    v_accvgpr_write_b32 a80, v37
    v_accvgpr_read_b32 v37, a89
    v_accvgpr_write_b32 a81, v37
    v_accvgpr_read_b32 v37, a90
    v_accvgpr_write_b32 a82, v37
    v_accvgpr_read_b32 v37, a91
    v_accvgpr_write_b32 a83, v37
    v_accvgpr_read_b32 v37, a92
    v_accvgpr_write_b32 a84, v37
    v_accvgpr_read_b32 v37, a93
    v_accvgpr_write_b32 a85, v37
    v_accvgpr_read_b32 v37, a94
    v_accvgpr_write_b32 a86, v37
    v_accvgpr_read_b32 v37, a95
    v_accvgpr_write_b32 a87, v37
    v_accvgpr_read_b32 v37, a104
    v_accvgpr_write_b32 a96, v37
    v_accvgpr_read_b32 v37, a105
    v_accvgpr_write_b32 a97, v37
    v_accvgpr_read_b32 v37, a106
    v_accvgpr_write_b32 a98, v37
    v_accvgpr_read_b32 v37, a107
    v_accvgpr_write_b32 a99, v37
    v_accvgpr_read_b32 v37, a108
    v_accvgpr_write_b32 a100, v37
    v_accvgpr_read_b32 v37, a109
    v_accvgpr_write_b32 a101, v37
    v_accvgpr_read_b32 v37, a110
    v_accvgpr_write_b32 a102, v37
    v_accvgpr_read_b32 v37, a111
    v_accvgpr_write_b32 a103, v37
K1F_X2:
    v_accvgpr_write_b32 a8, v118
    v_accvgpr_write_b32 a9, v119
    v_accvgpr_write_b32 a24, v120
    v_accvgpr_write_b32 a25, v121
    v_accvgpr_write_b32 a40, v122
    v_accvgpr_write_b32 a41, v123
    v_accvgpr_write_b32 a56, v124
    v_accvgpr_write_b32 a57, v125
    v_accvgpr_write_b32 a72, v126
    v_accvgpr_write_b32 a73, v127
    v_accvgpr_write_b32 a88, v128
    v_accvgpr_write_b32 a89, v129
    v_accvgpr_write_b32 a104, v130
    v_accvgpr_write_b32 a105, v131
    s_waitcnt lgkmcnt(0)
    s_barrier
    ds_read_b128 v[80:83], v36 offset:0
    ds_read_b128 v[84:87], v36 offset:1024
    ds_read_b128 v[88:91], v36 offset:2048
    ds_read_b128 v[92:95], v36 offset:3072
    ds_read_b128 v[96:99], v36 offset:4096
    ds_read_b128 v[100:103], v36 offset:5120
    ds_read_b128 v[104:107], v36 offset:6144
    ds_read_b128 v[108:111], v36 offset:7168
    ds_read_b128 v[112:115], v36 offset:8192
    ds_read_b128 v[116:119], v36 offset:9216
    ds_read_b128 v[120:123], v36 offset:10240
    ds_read_b128 v[124:127], v36 offset:11264
    ds_read_b128 v[128:131], v36 offset:12288
    ds_read_b128 v[132:135], v36 offset:13312
    s_waitcnt lgkmcnt(0)
    s_lshl_b32 s52, s3, 7
    s_lshl_b32 s53, s49, 6
    s_add_u32 s52, s52, s53
    s_lshl_b32 s53, s61, 5
    s_add_u32 s52, s52, s53
    v_add_u32 v11, s52, v3
    v_mul_u32_u24 v11, 3584, v11
    v_add_u32 v11, v11, v14
    v_add_u32 v12, 57344, v11
    s_lshl_b32 s53, s49, 6
    s_lshl_b32 s52, s61, 5
    s_add_u32 s53, s53, s52
    v_add_u32 v15, s53, v3
    v_mul_u32_u24 v15, 464, v15
    s_mul_i32 s53, s50, 224
    v_lshl_add_u32 v16, v4, 3, s53
    v_add_u32 v15, v15, v16
    s_barrier
    s_mov_b32 s54, 0x3f4c422a
    s_mov_b32 s55, 0x3d122279
    s_mov_b32 s56, 0xc038aa3b
    s_waitcnt vmcnt(0)
    s_nop 7
    v_mov_b32 v76, s54
    v_mov_b32 v77, s54
    v_mov_b32 v56, s55
    v_mov_b32 v57, s55
    v_mov_b32 v58, s56
    v_mov_b32 v59, s56
    v_mov_b32 v34, 1.0
    v_mov_b32 v35, 1.0
    v_accvgpr_read_b32 v37, a8
    v_lshlrev_b32 v60, 16, v37
    v_and_b32 v61, 0xffff0000, v37
    v_accvgpr_read_b32 v37, a9
    v_lshlrev_b32 v62, 16, v37
    v_and_b32 v63, 0xffff0000, v37
    v_accvgpr_read_b32 v40, a0
    v_accvgpr_read_b32 v41, a1
    v_accvgpr_read_b32 v42, a2
    v_accvgpr_read_b32 v43, a3
    v_accvgpr_read_b32 v44, a4
    v_accvgpr_read_b32 v45, a5
    v_accvgpr_read_b32 v46, a6
    v_accvgpr_read_b32 v47, a7
    v_add_f32 v40, v40, v80
    v_add_f32 v41, v41, v81
    v_add_f32 v42, v42, v82
    v_add_f32 v43, v43, v83
    v_add_f32 v44, v44, v84
    v_add_f32 v45, v45, v85
    v_add_f32 v46, v46, v86
    v_add_f32 v47, v47, v87
    v_cvt_pk_bf16_f32 v64, v40, v41
    v_cvt_pk_bf16_f32 v65, v42, v43
    v_cvt_pk_bf16_f32 v66, v44, v45
    v_cvt_pk_bf16_f32 v67, v46, v47
    v_lshlrev_b32 v40, 16, v64
    v_and_b32 v41, 0xffff0000, v64
    v_lshlrev_b32 v42, 16, v65
    v_and_b32 v43, 0xffff0000, v65
    v_lshlrev_b32 v44, 16, v66
    v_and_b32 v45, 0xffff0000, v66
    v_lshlrev_b32 v46, 16, v67
    v_and_b32 v47, 0xffff0000, v67
    v_add_f32 v40, v40, v60
    v_add_f32 v41, v41, v61
    v_add_f32 v42, v42, v62
    v_add_f32 v43, v43, v63
    v_add_f32 v44, v44, v60
    v_add_f32 v45, v45, v61
    v_add_f32 v46, v46, v62
    v_add_f32 v47, v47, v63
    v_cvt_pk_bf16_f32 v64, v40, v41
    v_cvt_pk_bf16_f32 v65, v42, v43
    v_cvt_pk_bf16_f32 v66, v44, v45
    v_cvt_pk_bf16_f32 v67, v46, v47
    v_lshlrev_b32 v40, 16, v64
    v_and_b32 v41, 0xffff0000, v64
    v_lshlrev_b32 v42, 16, v65
    v_and_b32 v43, 0xffff0000, v65
    v_lshlrev_b32 v44, 16, v66
    v_and_b32 v45, 0xffff0000, v66
    v_lshlrev_b32 v46, 16, v67
    v_and_b32 v47, 0xffff0000, v67
    v_mul_f32 v48, v40, v40
    v_mul_f32 v49, v41, v41
    v_mul_f32 v50, v42, v42
    v_mul_f32 v51, v43, v43
    v_mul_f32 v52, v44, v44
    v_mul_f32 v53, v45, v45
    v_mul_f32 v54, v46, v46
    v_mul_f32 v55, v47, v47
    v_fma_f32 v48, v48, v56, v76
    v_fma_f32 v49, v49, v56, v76
    v_fma_f32 v50, v50, v56, v76
    v_fma_f32 v51, v51, v56, v76
    v_fma_f32 v52, v52, v56, v76
    v_fma_f32 v53, v53, v56, v76
    v_fma_f32 v54, v54, v56, v76
    v_fma_f32 v55, v55, v56, v76
    v_mul_f32 v48, v48, v40
    v_mul_f32 v49, v49, v41
    v_mul_f32 v50, v50, v42
    v_mul_f32 v51, v51, v43
    v_mul_f32 v52, v52, v44
    v_mul_f32 v53, v53, v45
    v_mul_f32 v54, v54, v46
    v_mul_f32 v55, v55, v47
    v_mul_f32 v48, v48, v58
    v_mul_f32 v49, v49, v58
    v_mul_f32 v50, v50, v58
    v_mul_f32 v51, v51, v58
    v_mul_f32 v52, v52, v58
    v_mul_f32 v53, v53, v58
    v_mul_f32 v54, v54, v58
    v_mul_f32 v55, v55, v58
    v_exp_f32 v48, v48
    v_exp_f32 v49, v49
    v_exp_f32 v50, v50
    v_exp_f32 v51, v51
    v_exp_f32 v52, v52
    v_exp_f32 v53, v53
    v_exp_f32 v54, v54
    v_exp_f32 v55, v55
    v_add_f32 v48, 1.0, v48
    v_add_f32 v49, 1.0, v49
    v_add_f32 v50, 1.0, v50
    v_add_f32 v51, 1.0, v51
    v_add_f32 v52, 1.0, v52
    v_add_f32 v53, 1.0, v53
    v_add_f32 v54, 1.0, v54
    v_add_f32 v55, 1.0, v55
    v_rcp_f32 v48, v48
    v_rcp_f32 v49, v49
    v_rcp_f32 v50, v50
    v_rcp_f32 v51, v51
    v_rcp_f32 v52, v52
    v_rcp_f32 v53, v53
    v_rcp_f32 v54, v54
    v_rcp_f32 v55, v55
    v_mul_f32 v48, v48, v40
    v_mul_f32 v49, v49, v41
    v_mul_f32 v50, v50, v42
    v_mul_f32 v51, v51, v43
    v_mul_f32 v52, v52, v44
    v_mul_f32 v53, v53, v45
    v_mul_f32 v54, v54, v46
    v_mul_f32 v55, v55, v47
    v_cvt_pk_bf16_f32 v68, v48, v49
    v_cvt_pk_bf16_f32 v69, v50, v51
    v_cvt_pk_bf16_f32 v70, v52, v53
    v_cvt_pk_bf16_f32 v71, v54, v55
    ds_write_b64 v15, v[68:69] offset:0
    ds_write_b64 v15, v[70:71] offset:7424
    v_accvgpr_read_b32 v37, a24
    v_lshlrev_b32 v60, 16, v37
    v_and_b32 v61, 0xffff0000, v37
    v_accvgpr_read_b32 v37, a25
    v_lshlrev_b32 v62, 16, v37
    v_and_b32 v63, 0xffff0000, v37
    v_accvgpr_read_b32 v40, a16
    v_accvgpr_read_b32 v41, a17
    v_accvgpr_read_b32 v42, a18
    v_accvgpr_read_b32 v43, a19
    v_accvgpr_read_b32 v44, a20
    v_accvgpr_read_b32 v45, a21
    v_accvgpr_read_b32 v46, a22
    v_accvgpr_read_b32 v47, a23
    v_add_f32 v40, v40, v88
    v_add_f32 v41, v41, v89
    v_add_f32 v42, v42, v90
    v_add_f32 v43, v43, v91
    v_add_f32 v44, v44, v92
    v_add_f32 v45, v45, v93
    v_add_f32 v46, v46, v94
    v_add_f32 v47, v47, v95
    v_cvt_pk_bf16_f32 v64, v40, v41
    v_cvt_pk_bf16_f32 v65, v42, v43
    v_cvt_pk_bf16_f32 v66, v44, v45
    v_cvt_pk_bf16_f32 v67, v46, v47
    v_lshlrev_b32 v40, 16, v64
    v_and_b32 v41, 0xffff0000, v64
    v_lshlrev_b32 v42, 16, v65
    v_and_b32 v43, 0xffff0000, v65
    v_lshlrev_b32 v44, 16, v66
    v_and_b32 v45, 0xffff0000, v66
    v_lshlrev_b32 v46, 16, v67
    v_and_b32 v47, 0xffff0000, v67
    v_add_f32 v40, v40, v60
    v_add_f32 v41, v41, v61
    v_add_f32 v42, v42, v62
    v_add_f32 v43, v43, v63
    v_add_f32 v44, v44, v60
    v_add_f32 v45, v45, v61
    v_add_f32 v46, v46, v62
    v_add_f32 v47, v47, v63
    v_cvt_pk_bf16_f32 v64, v40, v41
    v_cvt_pk_bf16_f32 v65, v42, v43
    v_cvt_pk_bf16_f32 v66, v44, v45
    v_cvt_pk_bf16_f32 v67, v46, v47
    v_lshlrev_b32 v40, 16, v64
    v_and_b32 v41, 0xffff0000, v64
    v_lshlrev_b32 v42, 16, v65
    v_and_b32 v43, 0xffff0000, v65
    v_lshlrev_b32 v44, 16, v66
    v_and_b32 v45, 0xffff0000, v66
    v_lshlrev_b32 v46, 16, v67
    v_and_b32 v47, 0xffff0000, v67
    v_mul_f32 v48, v40, v40
    v_mul_f32 v49, v41, v41
    v_mul_f32 v50, v42, v42
    v_mul_f32 v51, v43, v43
    v_mul_f32 v52, v44, v44
    v_mul_f32 v53, v45, v45
    v_mul_f32 v54, v46, v46
    v_mul_f32 v55, v47, v47
    v_fma_f32 v48, v48, v56, v76
    v_fma_f32 v49, v49, v56, v76
    v_fma_f32 v50, v50, v56, v76
    v_fma_f32 v51, v51, v56, v76
    v_fma_f32 v52, v52, v56, v76
    v_fma_f32 v53, v53, v56, v76
    v_fma_f32 v54, v54, v56, v76
    v_fma_f32 v55, v55, v56, v76
    v_mul_f32 v48, v48, v40
    v_mul_f32 v49, v49, v41
    v_mul_f32 v50, v50, v42
    v_mul_f32 v51, v51, v43
    v_mul_f32 v52, v52, v44
    v_mul_f32 v53, v53, v45
    v_mul_f32 v54, v54, v46
    v_mul_f32 v55, v55, v47
    v_mul_f32 v48, v48, v58
    v_mul_f32 v49, v49, v58
    v_mul_f32 v50, v50, v58
    v_mul_f32 v51, v51, v58
    v_mul_f32 v52, v52, v58
    v_mul_f32 v53, v53, v58
    v_mul_f32 v54, v54, v58
    v_mul_f32 v55, v55, v58
    v_exp_f32 v48, v48
    v_exp_f32 v49, v49
    v_exp_f32 v50, v50
    v_exp_f32 v51, v51
    v_exp_f32 v52, v52
    v_exp_f32 v53, v53
    v_exp_f32 v54, v54
    v_exp_f32 v55, v55
    v_add_f32 v48, 1.0, v48
    v_add_f32 v49, 1.0, v49
    v_add_f32 v50, 1.0, v50
    v_add_f32 v51, 1.0, v51
    v_add_f32 v52, 1.0, v52
    v_add_f32 v53, 1.0, v53
    v_add_f32 v54, 1.0, v54
    v_add_f32 v55, 1.0, v55
    v_rcp_f32 v48, v48
    v_rcp_f32 v49, v49
    v_rcp_f32 v50, v50
    v_rcp_f32 v51, v51
    v_rcp_f32 v52, v52
    v_rcp_f32 v53, v53
    v_rcp_f32 v54, v54
    v_rcp_f32 v55, v55
    v_mul_f32 v48, v48, v40
    v_mul_f32 v49, v49, v41
    v_mul_f32 v50, v50, v42
    v_mul_f32 v51, v51, v43
    v_mul_f32 v52, v52, v44
    v_mul_f32 v53, v53, v45
    v_mul_f32 v54, v54, v46
    v_mul_f32 v55, v55, v47
    v_cvt_pk_bf16_f32 v68, v48, v49
    v_cvt_pk_bf16_f32 v69, v50, v51
    v_cvt_pk_bf16_f32 v70, v52, v53
    v_cvt_pk_bf16_f32 v71, v54, v55
    ds_write_b64 v15, v[68:69] offset:32
    ds_write_b64 v15, v[70:71] offset:7456
    v_accvgpr_read_b32 v37, a40
    v_lshlrev_b32 v60, 16, v37
    v_and_b32 v61, 0xffff0000, v37
    v_accvgpr_read_b32 v37, a41
    v_lshlrev_b32 v62, 16, v37
    v_and_b32 v63, 0xffff0000, v37
    v_accvgpr_read_b32 v40, a32
    v_accvgpr_read_b32 v41, a33
    v_accvgpr_read_b32 v42, a34
    v_accvgpr_read_b32 v43, a35
    v_accvgpr_read_b32 v44, a36
    v_accvgpr_read_b32 v45, a37
    v_accvgpr_read_b32 v46, a38
    v_accvgpr_read_b32 v47, a39
    v_add_f32 v40, v40, v96
    v_add_f32 v41, v41, v97
    v_add_f32 v42, v42, v98
    v_add_f32 v43, v43, v99
    v_add_f32 v44, v44, v100
    v_add_f32 v45, v45, v101
    v_add_f32 v46, v46, v102
    v_add_f32 v47, v47, v103
    v_cvt_pk_bf16_f32 v64, v40, v41
    v_cvt_pk_bf16_f32 v65, v42, v43
    v_cvt_pk_bf16_f32 v66, v44, v45
    v_cvt_pk_bf16_f32 v67, v46, v47
    v_lshlrev_b32 v40, 16, v64
    v_and_b32 v41, 0xffff0000, v64
    v_lshlrev_b32 v42, 16, v65
    v_and_b32 v43, 0xffff0000, v65
    v_lshlrev_b32 v44, 16, v66
    v_and_b32 v45, 0xffff0000, v66
    v_lshlrev_b32 v46, 16, v67
    v_and_b32 v47, 0xffff0000, v67
    v_add_f32 v40, v40, v60
    v_add_f32 v41, v41, v61
    v_add_f32 v42, v42, v62
    v_add_f32 v43, v43, v63
    v_add_f32 v44, v44, v60
    v_add_f32 v45, v45, v61
    v_add_f32 v46, v46, v62
    v_add_f32 v47, v47, v63
    v_cvt_pk_bf16_f32 v64, v40, v41
    v_cvt_pk_bf16_f32 v65, v42, v43
    v_cvt_pk_bf16_f32 v66, v44, v45
    v_cvt_pk_bf16_f32 v67, v46, v47
    v_lshlrev_b32 v40, 16, v64
    v_and_b32 v41, 0xffff0000, v64
    v_lshlrev_b32 v42, 16, v65
    v_and_b32 v43, 0xffff0000, v65
    v_lshlrev_b32 v44, 16, v66
    v_and_b32 v45, 0xffff0000, v66
    v_lshlrev_b32 v46, 16, v67
    v_and_b32 v47, 0xffff0000, v67
    v_mul_f32 v48, v40, v40
    v_mul_f32 v49, v41, v41
    v_mul_f32 v50, v42, v42
    v_mul_f32 v51, v43, v43
    v_mul_f32 v52, v44, v44
    v_mul_f32 v53, v45, v45
    v_mul_f32 v54, v46, v46
    v_mul_f32 v55, v47, v47
    v_fma_f32 v48, v48, v56, v76
    v_fma_f32 v49, v49, v56, v76
    v_fma_f32 v50, v50, v56, v76
    v_fma_f32 v51, v51, v56, v76
    v_fma_f32 v52, v52, v56, v76
    v_fma_f32 v53, v53, v56, v76
    v_fma_f32 v54, v54, v56, v76
    v_fma_f32 v55, v55, v56, v76
    v_mul_f32 v48, v48, v40
    v_mul_f32 v49, v49, v41
    v_mul_f32 v50, v50, v42
    v_mul_f32 v51, v51, v43
    v_mul_f32 v52, v52, v44
    v_mul_f32 v53, v53, v45
    v_mul_f32 v54, v54, v46
    v_mul_f32 v55, v55, v47
    v_mul_f32 v48, v48, v58
    v_mul_f32 v49, v49, v58
    v_mul_f32 v50, v50, v58
    v_mul_f32 v51, v51, v58
    v_mul_f32 v52, v52, v58
    v_mul_f32 v53, v53, v58
    v_mul_f32 v54, v54, v58
    v_mul_f32 v55, v55, v58
    v_exp_f32 v48, v48
    v_exp_f32 v49, v49
    v_exp_f32 v50, v50
    v_exp_f32 v51, v51
    v_exp_f32 v52, v52
    v_exp_f32 v53, v53
    v_exp_f32 v54, v54
    v_exp_f32 v55, v55
    v_add_f32 v48, 1.0, v48
    v_add_f32 v49, 1.0, v49
    v_add_f32 v50, 1.0, v50
    v_add_f32 v51, 1.0, v51
    v_add_f32 v52, 1.0, v52
    v_add_f32 v53, 1.0, v53
    v_add_f32 v54, 1.0, v54
    v_add_f32 v55, 1.0, v55
    v_rcp_f32 v48, v48
    v_rcp_f32 v49, v49
    v_rcp_f32 v50, v50
    v_rcp_f32 v51, v51
    v_rcp_f32 v52, v52
    v_rcp_f32 v53, v53
    v_rcp_f32 v54, v54
    v_rcp_f32 v55, v55
    v_mul_f32 v48, v48, v40
    v_mul_f32 v49, v49, v41
    v_mul_f32 v50, v50, v42
    v_mul_f32 v51, v51, v43
    v_mul_f32 v52, v52, v44
    v_mul_f32 v53, v53, v45
    v_mul_f32 v54, v54, v46
    v_mul_f32 v55, v55, v47
    v_cvt_pk_bf16_f32 v68, v48, v49
    v_cvt_pk_bf16_f32 v69, v50, v51
    v_cvt_pk_bf16_f32 v70, v52, v53
    v_cvt_pk_bf16_f32 v71, v54, v55
    ds_write_b64 v15, v[68:69] offset:64
    ds_write_b64 v15, v[70:71] offset:7488
    v_accvgpr_read_b32 v37, a56
    v_lshlrev_b32 v60, 16, v37
    v_and_b32 v61, 0xffff0000, v37
    v_accvgpr_read_b32 v37, a57
    v_lshlrev_b32 v62, 16, v37
    v_and_b32 v63, 0xffff0000, v37
    v_accvgpr_read_b32 v40, a48
    v_accvgpr_read_b32 v41, a49
    v_accvgpr_read_b32 v42, a50
    v_accvgpr_read_b32 v43, a51
    v_accvgpr_read_b32 v44, a52
    v_accvgpr_read_b32 v45, a53
    v_accvgpr_read_b32 v46, a54
    v_accvgpr_read_b32 v47, a55
    v_add_f32 v40, v40, v104
    v_add_f32 v41, v41, v105
    v_add_f32 v42, v42, v106
    v_add_f32 v43, v43, v107
    v_add_f32 v44, v44, v108
    v_add_f32 v45, v45, v109
    v_add_f32 v46, v46, v110
    v_add_f32 v47, v47, v111
    v_cvt_pk_bf16_f32 v64, v40, v41
    v_cvt_pk_bf16_f32 v65, v42, v43
    v_cvt_pk_bf16_f32 v66, v44, v45
    v_cvt_pk_bf16_f32 v67, v46, v47
    v_lshlrev_b32 v40, 16, v64
    v_and_b32 v41, 0xffff0000, v64
    v_lshlrev_b32 v42, 16, v65
    v_and_b32 v43, 0xffff0000, v65
    v_lshlrev_b32 v44, 16, v66
    v_and_b32 v45, 0xffff0000, v66
    v_lshlrev_b32 v46, 16, v67
    v_and_b32 v47, 0xffff0000, v67
    v_add_f32 v40, v40, v60
    v_add_f32 v41, v41, v61
    v_add_f32 v42, v42, v62
    v_add_f32 v43, v43, v63
    v_add_f32 v44, v44, v60
    v_add_f32 v45, v45, v61
    v_add_f32 v46, v46, v62
    v_add_f32 v47, v47, v63
    v_cvt_pk_bf16_f32 v64, v40, v41
    v_cvt_pk_bf16_f32 v65, v42, v43
    v_cvt_pk_bf16_f32 v66, v44, v45
    v_cvt_pk_bf16_f32 v67, v46, v47
    v_lshlrev_b32 v40, 16, v64
    v_and_b32 v41, 0xffff0000, v64
    v_lshlrev_b32 v42, 16, v65
    v_and_b32 v43, 0xffff0000, v65
    v_lshlrev_b32 v44, 16, v66
    v_and_b32 v45, 0xffff0000, v66
    v_lshlrev_b32 v46, 16, v67
    v_and_b32 v47, 0xffff0000, v67
    v_mul_f32 v48, v40, v40
    v_mul_f32 v49, v41, v41
    v_mul_f32 v50, v42, v42
    v_mul_f32 v51, v43, v43
    v_mul_f32 v52, v44, v44
    v_mul_f32 v53, v45, v45
    v_mul_f32 v54, v46, v46
    v_mul_f32 v55, v47, v47
    v_fma_f32 v48, v48, v56, v76
    v_fma_f32 v49, v49, v56, v76
    v_fma_f32 v50, v50, v56, v76
    v_fma_f32 v51, v51, v56, v76
    v_fma_f32 v52, v52, v56, v76
    v_fma_f32 v53, v53, v56, v76
    v_fma_f32 v54, v54, v56, v76
    v_fma_f32 v55, v55, v56, v76
    v_mul_f32 v48, v48, v40
    v_mul_f32 v49, v49, v41
    v_mul_f32 v50, v50, v42
    v_mul_f32 v51, v51, v43
    v_mul_f32 v52, v52, v44
    v_mul_f32 v53, v53, v45
    v_mul_f32 v54, v54, v46
    v_mul_f32 v55, v55, v47
    v_mul_f32 v48, v48, v58
    v_mul_f32 v49, v49, v58
    v_mul_f32 v50, v50, v58
    v_mul_f32 v51, v51, v58
    v_mul_f32 v52, v52, v58
    v_mul_f32 v53, v53, v58
    v_mul_f32 v54, v54, v58
    v_mul_f32 v55, v55, v58
    v_exp_f32 v48, v48
    v_exp_f32 v49, v49
    v_exp_f32 v50, v50
    v_exp_f32 v51, v51
    v_exp_f32 v52, v52
    v_exp_f32 v53, v53
    v_exp_f32 v54, v54
    v_exp_f32 v55, v55
    v_add_f32 v48, 1.0, v48
    v_add_f32 v49, 1.0, v49
    v_add_f32 v50, 1.0, v50
    v_add_f32 v51, 1.0, v51
    v_add_f32 v52, 1.0, v52
    v_add_f32 v53, 1.0, v53
    v_add_f32 v54, 1.0, v54
    v_add_f32 v55, 1.0, v55
    v_rcp_f32 v48, v48
    v_rcp_f32 v49, v49
    v_rcp_f32 v50, v50
    v_rcp_f32 v51, v51
    v_rcp_f32 v52, v52
    v_rcp_f32 v53, v53
    v_rcp_f32 v54, v54
    v_rcp_f32 v55, v55
    v_mul_f32 v48, v48, v40
    v_mul_f32 v49, v49, v41
    v_mul_f32 v50, v50, v42
    v_mul_f32 v51, v51, v43
    v_mul_f32 v52, v52, v44
    v_mul_f32 v53, v53, v45
    v_mul_f32 v54, v54, v46
    v_mul_f32 v55, v55, v47
    v_cvt_pk_bf16_f32 v68, v48, v49
    v_cvt_pk_bf16_f32 v69, v50, v51
    v_cvt_pk_bf16_f32 v70, v52, v53
    v_cvt_pk_bf16_f32 v71, v54, v55
    ds_write_b64 v15, v[68:69] offset:96
    ds_write_b64 v15, v[70:71] offset:7520
    v_accvgpr_read_b32 v37, a72
    v_lshlrev_b32 v60, 16, v37
    v_and_b32 v61, 0xffff0000, v37
    v_accvgpr_read_b32 v37, a73
    v_lshlrev_b32 v62, 16, v37
    v_and_b32 v63, 0xffff0000, v37
    v_accvgpr_read_b32 v40, a64
    v_accvgpr_read_b32 v41, a65
    v_accvgpr_read_b32 v42, a66
    v_accvgpr_read_b32 v43, a67
    v_accvgpr_read_b32 v44, a68
    v_accvgpr_read_b32 v45, a69
    v_accvgpr_read_b32 v46, a70
    v_accvgpr_read_b32 v47, a71
    v_add_f32 v40, v40, v112
    v_add_f32 v41, v41, v113
    v_add_f32 v42, v42, v114
    v_add_f32 v43, v43, v115
    v_add_f32 v44, v44, v116
    v_add_f32 v45, v45, v117
    v_add_f32 v46, v46, v118
    v_add_f32 v47, v47, v119
    v_cvt_pk_bf16_f32 v64, v40, v41
    v_cvt_pk_bf16_f32 v65, v42, v43
    v_cvt_pk_bf16_f32 v66, v44, v45
    v_cvt_pk_bf16_f32 v67, v46, v47
    v_lshlrev_b32 v40, 16, v64
    v_and_b32 v41, 0xffff0000, v64
    v_lshlrev_b32 v42, 16, v65
    v_and_b32 v43, 0xffff0000, v65
    v_lshlrev_b32 v44, 16, v66
    v_and_b32 v45, 0xffff0000, v66
    v_lshlrev_b32 v46, 16, v67
    v_and_b32 v47, 0xffff0000, v67
    v_add_f32 v40, v40, v60
    v_add_f32 v41, v41, v61
    v_add_f32 v42, v42, v62
    v_add_f32 v43, v43, v63
    v_add_f32 v44, v44, v60
    v_add_f32 v45, v45, v61
    v_add_f32 v46, v46, v62
    v_add_f32 v47, v47, v63
    v_cvt_pk_bf16_f32 v64, v40, v41
    v_cvt_pk_bf16_f32 v65, v42, v43
    v_cvt_pk_bf16_f32 v66, v44, v45
    v_cvt_pk_bf16_f32 v67, v46, v47
    v_lshlrev_b32 v40, 16, v64
    v_and_b32 v41, 0xffff0000, v64
    v_lshlrev_b32 v42, 16, v65
    v_and_b32 v43, 0xffff0000, v65
    v_lshlrev_b32 v44, 16, v66
    v_and_b32 v45, 0xffff0000, v66
    v_lshlrev_b32 v46, 16, v67
    v_and_b32 v47, 0xffff0000, v67
    v_mul_f32 v48, v40, v40
    v_mul_f32 v49, v41, v41
    v_mul_f32 v50, v42, v42
    v_mul_f32 v51, v43, v43
    v_mul_f32 v52, v44, v44
    v_mul_f32 v53, v45, v45
    v_mul_f32 v54, v46, v46
    v_mul_f32 v55, v47, v47
    v_fma_f32 v48, v48, v56, v76
    v_fma_f32 v49, v49, v56, v76
    v_fma_f32 v50, v50, v56, v76
    v_fma_f32 v51, v51, v56, v76
    v_fma_f32 v52, v52, v56, v76
    v_fma_f32 v53, v53, v56, v76
    v_fma_f32 v54, v54, v56, v76
    v_fma_f32 v55, v55, v56, v76
    v_mul_f32 v48, v48, v40
    v_mul_f32 v49, v49, v41
    v_mul_f32 v50, v50, v42
    v_mul_f32 v51, v51, v43
    v_mul_f32 v52, v52, v44
    v_mul_f32 v53, v53, v45
    v_mul_f32 v54, v54, v46
    v_mul_f32 v55, v55, v47
    v_mul_f32 v48, v48, v58
    v_mul_f32 v49, v49, v58
    v_mul_f32 v50, v50, v58
    v_mul_f32 v51, v51, v58
    v_mul_f32 v52, v52, v58
    v_mul_f32 v53, v53, v58
    v_mul_f32 v54, v54, v58
    v_mul_f32 v55, v55, v58
    v_exp_f32 v48, v48
    v_exp_f32 v49, v49
    v_exp_f32 v50, v50
    v_exp_f32 v51, v51
    v_exp_f32 v52, v52
    v_exp_f32 v53, v53
    v_exp_f32 v54, v54
    v_exp_f32 v55, v55
    v_add_f32 v48, 1.0, v48
    v_add_f32 v49, 1.0, v49
    v_add_f32 v50, 1.0, v50
    v_add_f32 v51, 1.0, v51
    v_add_f32 v52, 1.0, v52
    v_add_f32 v53, 1.0, v53
    v_add_f32 v54, 1.0, v54
    v_add_f32 v55, 1.0, v55
    v_rcp_f32 v48, v48
    v_rcp_f32 v49, v49
    v_rcp_f32 v50, v50
    v_rcp_f32 v51, v51
    v_rcp_f32 v52, v52
    v_rcp_f32 v53, v53
    v_rcp_f32 v54, v54
    v_rcp_f32 v55, v55
    v_mul_f32 v48, v48, v40
    v_mul_f32 v49, v49, v41
    v_mul_f32 v50, v50, v42
    v_mul_f32 v51, v51, v43
    v_mul_f32 v52, v52, v44
    v_mul_f32 v53, v53, v45
    v_mul_f32 v54, v54, v46
    v_mul_f32 v55, v55, v47
    v_cvt_pk_bf16_f32 v68, v48, v49
    v_cvt_pk_bf16_f32 v69, v50, v51
    v_cvt_pk_bf16_f32 v70, v52, v53
    v_cvt_pk_bf16_f32 v71, v54, v55
    ds_write_b64 v15, v[68:69] offset:128
    ds_write_b64 v15, v[70:71] offset:7552
    v_accvgpr_read_b32 v37, a88
    v_lshlrev_b32 v60, 16, v37
    v_and_b32 v61, 0xffff0000, v37
    v_accvgpr_read_b32 v37, a89
    v_lshlrev_b32 v62, 16, v37
    v_and_b32 v63, 0xffff0000, v37
    v_accvgpr_read_b32 v40, a80
    v_accvgpr_read_b32 v41, a81
    v_accvgpr_read_b32 v42, a82
    v_accvgpr_read_b32 v43, a83
    v_accvgpr_read_b32 v44, a84
    v_accvgpr_read_b32 v45, a85
    v_accvgpr_read_b32 v46, a86
    v_accvgpr_read_b32 v47, a87
    v_add_f32 v40, v40, v120
    v_add_f32 v41, v41, v121
    v_add_f32 v42, v42, v122
    v_add_f32 v43, v43, v123
    v_add_f32 v44, v44, v124
    v_add_f32 v45, v45, v125
    v_add_f32 v46, v46, v126
    v_add_f32 v47, v47, v127
    v_cvt_pk_bf16_f32 v64, v40, v41
    v_cvt_pk_bf16_f32 v65, v42, v43
    v_cvt_pk_bf16_f32 v66, v44, v45
    v_cvt_pk_bf16_f32 v67, v46, v47
    v_lshlrev_b32 v40, 16, v64
    v_and_b32 v41, 0xffff0000, v64
    v_lshlrev_b32 v42, 16, v65
    v_and_b32 v43, 0xffff0000, v65
    v_lshlrev_b32 v44, 16, v66
    v_and_b32 v45, 0xffff0000, v66
    v_lshlrev_b32 v46, 16, v67
    v_and_b32 v47, 0xffff0000, v67
    v_add_f32 v40, v40, v60
    v_add_f32 v41, v41, v61
    v_add_f32 v42, v42, v62
    v_add_f32 v43, v43, v63
    v_add_f32 v44, v44, v60
    v_add_f32 v45, v45, v61
    v_add_f32 v46, v46, v62
    v_add_f32 v47, v47, v63
    v_cvt_pk_bf16_f32 v64, v40, v41
    v_cvt_pk_bf16_f32 v65, v42, v43
    v_cvt_pk_bf16_f32 v66, v44, v45
    v_cvt_pk_bf16_f32 v67, v46, v47
    v_lshlrev_b32 v40, 16, v64
    v_and_b32 v41, 0xffff0000, v64
    v_lshlrev_b32 v42, 16, v65
    v_and_b32 v43, 0xffff0000, v65
    v_lshlrev_b32 v44, 16, v66
    v_and_b32 v45, 0xffff0000, v66
    v_lshlrev_b32 v46, 16, v67
    v_and_b32 v47, 0xffff0000, v67
    v_mul_f32 v48, v40, v40
    v_mul_f32 v49, v41, v41
    v_mul_f32 v50, v42, v42
    v_mul_f32 v51, v43, v43
    v_mul_f32 v52, v44, v44
    v_mul_f32 v53, v45, v45
    v_mul_f32 v54, v46, v46
    v_mul_f32 v55, v47, v47
    v_fma_f32 v48, v48, v56, v76
    v_fma_f32 v49, v49, v56, v76
    v_fma_f32 v50, v50, v56, v76
    v_fma_f32 v51, v51, v56, v76
    v_fma_f32 v52, v52, v56, v76
    v_fma_f32 v53, v53, v56, v76
    v_fma_f32 v54, v54, v56, v76
    v_fma_f32 v55, v55, v56, v76
    v_mul_f32 v48, v48, v40
    v_mul_f32 v49, v49, v41
    v_mul_f32 v50, v50, v42
    v_mul_f32 v51, v51, v43
    v_mul_f32 v52, v52, v44
    v_mul_f32 v53, v53, v45
    v_mul_f32 v54, v54, v46
    v_mul_f32 v55, v55, v47
    v_mul_f32 v48, v48, v58
    v_mul_f32 v49, v49, v58
    v_mul_f32 v50, v50, v58
    v_mul_f32 v51, v51, v58
    v_mul_f32 v52, v52, v58
    v_mul_f32 v53, v53, v58
    v_mul_f32 v54, v54, v58
    v_mul_f32 v55, v55, v58
    v_exp_f32 v48, v48
    v_exp_f32 v49, v49
    v_exp_f32 v50, v50
    v_exp_f32 v51, v51
    v_exp_f32 v52, v52
    v_exp_f32 v53, v53
    v_exp_f32 v54, v54
    v_exp_f32 v55, v55
    v_add_f32 v48, 1.0, v48
    v_add_f32 v49, 1.0, v49
    v_add_f32 v50, 1.0, v50
    v_add_f32 v51, 1.0, v51
    v_add_f32 v52, 1.0, v52
    v_add_f32 v53, 1.0, v53
    v_add_f32 v54, 1.0, v54
    v_add_f32 v55, 1.0, v55
    v_rcp_f32 v48, v48
    v_rcp_f32 v49, v49
    v_rcp_f32 v50, v50
    v_rcp_f32 v51, v51
    v_rcp_f32 v52, v52
    v_rcp_f32 v53, v53
    v_rcp_f32 v54, v54
    v_rcp_f32 v55, v55
    v_mul_f32 v48, v48, v40
    v_mul_f32 v49, v49, v41
    v_mul_f32 v50, v50, v42
    v_mul_f32 v51, v51, v43
    v_mul_f32 v52, v52, v44
    v_mul_f32 v53, v53, v45
    v_mul_f32 v54, v54, v46
    v_mul_f32 v55, v55, v47
    v_cvt_pk_bf16_f32 v68, v48, v49
    v_cvt_pk_bf16_f32 v69, v50, v51
    v_cvt_pk_bf16_f32 v70, v52, v53
    v_cvt_pk_bf16_f32 v71, v54, v55
    ds_write_b64 v15, v[68:69] offset:160
    ds_write_b64 v15, v[70:71] offset:7584
    v_accvgpr_read_b32 v37, a104
    v_lshlrev_b32 v60, 16, v37
    v_and_b32 v61, 0xffff0000, v37
    v_accvgpr_read_b32 v37, a105
    v_lshlrev_b32 v62, 16, v37
    v_and_b32 v63, 0xffff0000, v37
    v_accvgpr_read_b32 v40, a96
    v_accvgpr_read_b32 v41, a97
    v_accvgpr_read_b32 v42, a98
    v_accvgpr_read_b32 v43, a99
    v_accvgpr_read_b32 v44, a100
    v_accvgpr_read_b32 v45, a101
    v_accvgpr_read_b32 v46, a102
    v_accvgpr_read_b32 v47, a103
    v_add_f32 v40, v40, v128
    v_add_f32 v41, v41, v129
    v_add_f32 v42, v42, v130
    v_add_f32 v43, v43, v131
    v_add_f32 v44, v44, v132
    v_add_f32 v45, v45, v133
    v_add_f32 v46, v46, v134
    v_add_f32 v47, v47, v135
    v_cvt_pk_bf16_f32 v64, v40, v41
    v_cvt_pk_bf16_f32 v65, v42, v43
    v_cvt_pk_bf16_f32 v66, v44, v45
    v_cvt_pk_bf16_f32 v67, v46, v47
    v_lshlrev_b32 v40, 16, v64
    v_and_b32 v41, 0xffff0000, v64
    v_lshlrev_b32 v42, 16, v65
    v_and_b32 v43, 0xffff0000, v65
    v_lshlrev_b32 v44, 16, v66
    v_and_b32 v45, 0xffff0000, v66
    v_lshlrev_b32 v46, 16, v67
    v_and_b32 v47, 0xffff0000, v67
    v_add_f32 v40, v40, v60
    v_add_f32 v41, v41, v61
    v_add_f32 v42, v42, v62
    v_add_f32 v43, v43, v63
    v_add_f32 v44, v44, v60
    v_add_f32 v45, v45, v61
    v_add_f32 v46, v46, v62
    v_add_f32 v47, v47, v63
    v_cvt_pk_bf16_f32 v64, v40, v41
    v_cvt_pk_bf16_f32 v65, v42, v43
    v_cvt_pk_bf16_f32 v66, v44, v45
    v_cvt_pk_bf16_f32 v67, v46, v47
    v_lshlrev_b32 v40, 16, v64
    v_and_b32 v41, 0xffff0000, v64
    v_lshlrev_b32 v42, 16, v65
    v_and_b32 v43, 0xffff0000, v65
    v_lshlrev_b32 v44, 16, v66
    v_and_b32 v45, 0xffff0000, v66
    v_lshlrev_b32 v46, 16, v67
    v_and_b32 v47, 0xffff0000, v67
    v_mul_f32 v48, v40, v40
    v_mul_f32 v49, v41, v41
    v_mul_f32 v50, v42, v42
    v_mul_f32 v51, v43, v43
    v_mul_f32 v52, v44, v44
    v_mul_f32 v53, v45, v45
    v_mul_f32 v54, v46, v46
    v_mul_f32 v55, v47, v47
    v_fma_f32 v48, v48, v56, v76
    v_fma_f32 v49, v49, v56, v76
    v_fma_f32 v50, v50, v56, v76
    v_fma_f32 v51, v51, v56, v76
    v_fma_f32 v52, v52, v56, v76
    v_fma_f32 v53, v53, v56, v76
    v_fma_f32 v54, v54, v56, v76
    v_fma_f32 v55, v55, v56, v76
    v_mul_f32 v48, v48, v40
    v_mul_f32 v49, v49, v41
    v_mul_f32 v50, v50, v42
    v_mul_f32 v51, v51, v43
    v_mul_f32 v52, v52, v44
    v_mul_f32 v53, v53, v45
    v_mul_f32 v54, v54, v46
    v_mul_f32 v55, v55, v47
    v_mul_f32 v48, v48, v58
    v_mul_f32 v49, v49, v58
    v_mul_f32 v50, v50, v58
    v_mul_f32 v51, v51, v58
    v_mul_f32 v52, v52, v58
    v_mul_f32 v53, v53, v58
    v_mul_f32 v54, v54, v58
    v_mul_f32 v55, v55, v58
    v_exp_f32 v48, v48
    v_exp_f32 v49, v49
    v_exp_f32 v50, v50
    v_exp_f32 v51, v51
    v_exp_f32 v52, v52
    v_exp_f32 v53, v53
    v_exp_f32 v54, v54
    v_exp_f32 v55, v55
    v_add_f32 v48, 1.0, v48
    v_add_f32 v49, 1.0, v49
    v_add_f32 v50, 1.0, v50
    v_add_f32 v51, 1.0, v51
    v_add_f32 v52, 1.0, v52
    v_add_f32 v53, 1.0, v53
    v_add_f32 v54, 1.0, v54
    v_add_f32 v55, 1.0, v55
    v_rcp_f32 v48, v48
    v_rcp_f32 v49, v49
    v_rcp_f32 v50, v50
    v_rcp_f32 v51, v51
    v_rcp_f32 v52, v52
    v_rcp_f32 v53, v53
    v_rcp_f32 v54, v54
    v_rcp_f32 v55, v55
    v_mul_f32 v48, v48, v40
    v_mul_f32 v49, v49, v41
    v_mul_f32 v50, v50, v42
    v_mul_f32 v51, v51, v43
    v_mul_f32 v52, v52, v44
    v_mul_f32 v53, v53, v45
    v_mul_f32 v54, v54, v46
    v_mul_f32 v55, v55, v47
    v_cvt_pk_bf16_f32 v68, v48, v49
    v_cvt_pk_bf16_f32 v69, v50, v51
    v_cvt_pk_bf16_f32 v70, v52, v53
    v_cvt_pk_bf16_f32 v71, v54, v55
    ds_write_b64 v15, v[68:69] offset:192
    ds_write_b64 v15, v[70:71] offset:7616
    s_waitcnt lgkmcnt(0)
    s_barrier
    s_lshl_b32 s52, s3, 7
    s_mul_i32 s52, s52, 3584
    s_add_u32 s52, s52, s7
    v_add_u32 v40, 0, v0
    v_mul_lo_u32 v41, v40, s48
    v_lshrrev_b32 v41, 16, v41
    v_mul_u32_u24 v42, 28, v41
    v_sub_u32 v42, v40, v42
    v_mul_u32_u24 v43, 464, v41
    v_lshl_add_u32 v43, v42, 4, v43
    ds_read_b128 v[60:63], v43
    v_mul_u32_u24 v43, 3584, v41
    v_lshl_add_u32 v50, v42, 4, v43
    v_add_u32 v40, 512, v0
    v_mul_lo_u32 v41, v40, s48
    v_lshrrev_b32 v41, 16, v41
    v_mul_u32_u24 v42, 28, v41
    v_sub_u32 v42, v40, v42
    v_mul_u32_u24 v43, 464, v41
    v_lshl_add_u32 v43, v42, 4, v43
    ds_read_b128 v[64:67], v43
    v_mul_u32_u24 v43, 3584, v41
    v_lshl_add_u32 v51, v42, 4, v43
    v_add_u32 v40, 1024, v0
    v_mul_lo_u32 v41, v40, s48
    v_lshrrev_b32 v41, 16, v41
    v_mul_u32_u24 v42, 28, v41
    v_sub_u32 v42, v40, v42
    v_mul_u32_u24 v43, 464, v41
    v_lshl_add_u32 v43, v42, 4, v43
    ds_read_b128 v[68:71], v43
    v_mul_u32_u24 v43, 3584, v41
    v_lshl_add_u32 v52, v42, 4, v43
    v_add_u32 v40, 1536, v0
    v_mul_lo_u32 v41, v40, s48
    v_lshrrev_b32 v41, 16, v41
    v_mul_u32_u24 v42, 28, v41
    v_sub_u32 v42, v40, v42
    v_mul_u32_u24 v43, 464, v41
    v_lshl_add_u32 v43, v42, 4, v43
    ds_read_b128 v[72:75], v43
    v_mul_u32_u24 v43, 3584, v41
    v_lshl_add_u32 v53, v42, 4, v43
    v_add_u32 v40, 2048, v0
    v_mul_lo_u32 v41, v40, s48
    v_lshrrev_b32 v41, 16, v41
    v_mul_u32_u24 v42, 28, v41
    v_sub_u32 v42, v40, v42
    v_mul_u32_u24 v43, 464, v41
    v_lshl_add_u32 v43, v42, 4, v43
    ds_read_b128 v[76:79], v43
    v_mul_u32_u24 v43, 3584, v41
    v_lshl_add_u32 v54, v42, 4, v43
    v_add_u32 v40, 2560, v0
    v_mul_lo_u32 v41, v40, s48
    v_lshrrev_b32 v41, 16, v41
    v_mul_u32_u24 v42, 28, v41
    v_sub_u32 v42, v40, v42
    v_mul_u32_u24 v43, 464, v41
    v_lshl_add_u32 v43, v42, 4, v43
    ds_read_b128 v[80:83], v43
    v_mul_u32_u24 v43, 3584, v41
    v_lshl_add_u32 v55, v42, 4, v43
    v_add_u32 v40, 3072, v0
    v_mul_lo_u32 v41, v40, s48
    v_lshrrev_b32 v41, 16, v41
    v_mul_u32_u24 v42, 28, v41
    v_sub_u32 v42, v40, v42
    v_mul_u32_u24 v43, 464, v41
    v_lshl_add_u32 v43, v42, 4, v43
    ds_read_b128 v[84:87], v43
    v_mul_u32_u24 v43, 3584, v41
    v_lshl_add_u32 v56, v42, 4, v43
    s_waitcnt lgkmcnt(0)
    buffer_store_dwordx4 v[60:63], v50, s[20:23], s52 offen
    buffer_store_dwordx4 v[64:67], v51, s[20:23], s52 offen
    buffer_store_dwordx4 v[68:71], v52, s[20:23], s52 offen
    buffer_store_dwordx4 v[72:75], v53, s[20:23], s52 offen
    buffer_store_dwordx4 v[76:79], v54, s[20:23], s52 offen
    buffer_store_dwordx4 v[80:83], v55, s[20:23], s52 offen
    buffer_store_dwordx4 v[84:87], v56, s[20:23], s52 offen
    s_branch K1_END
K1_SSM:
    s_mov_b32 s12, s30
    s_mov_b32 s13, s31
    s_mov_b32 s14, 524288
    s_mov_b32 s15, 0x00020000
    s_mov_b32 s16, s32
    s_mov_b32 s17, s33
    s_mov_b32 s18, 524288
    s_mov_b32 s19, 0x00020000
    s_mov_b32 s72, s40
    s_mov_b32 s73, s41
    s_mov_b32 s74, 1024
    s_mov_b32 s75, 0x00020000
    v_lshrrev_b32 v10, 5, v0
    s_lshl_b32 s7, s4, 4
    v_add_u32 v10, s7, v10
    v_lshlrev_b32 v11, 10, v10
    v_add_u32 v11, s6, v11
    v_and_b32 v12, 31, v0
    v_lshl_add_u32 v11, v12, 5, v11
    v_lshlrev_b32 v13, 5, v12
    buffer_load_dwordx4 v[40:43], v11, s[8:11], 0 offen
    buffer_load_dwordx4 v[44:47], v11, s[8:11], 0 offen offset:16
    buffer_load_dwordx4 v[48:51], v13, s[72:75], 0 offen
    buffer_load_dwordx4 v[52:55], v13, s[72:75], 0 offen offset:16
    v_mov_b32 v14, 0
    s_waitcnt vmcnt(0)
    v_lshlrev_b32 v60, 16, v40
    v_and_b32 v61, 0xffff0000, v40
    v_lshlrev_b32 v62, 16, v48
    v_and_b32 v63, 0xffff0000, v48
    v_mul_f32 v60, v60, v62
    v_mul_f32 v61, v61, v63
    v_cvt_pk_bf16_f32 v60, v60, v61
    v_lshlrev_b32 v61, 16, v60
    v_and_b32 v60, 0xffff0000, v60
    v_add_f32 v14, v14, v61
    v_add_f32 v14, v14, v60
    v_lshlrev_b32 v60, 16, v41
    v_and_b32 v61, 0xffff0000, v41
    v_lshlrev_b32 v62, 16, v49
    v_and_b32 v63, 0xffff0000, v49
    v_mul_f32 v60, v60, v62
    v_mul_f32 v61, v61, v63
    v_cvt_pk_bf16_f32 v60, v60, v61
    v_lshlrev_b32 v61, 16, v60
    v_and_b32 v60, 0xffff0000, v60
    v_add_f32 v14, v14, v61
    v_add_f32 v14, v14, v60
    v_lshlrev_b32 v60, 16, v42
    v_and_b32 v61, 0xffff0000, v42
    v_lshlrev_b32 v62, 16, v50
    v_and_b32 v63, 0xffff0000, v50
    v_mul_f32 v60, v60, v62
    v_mul_f32 v61, v61, v63
    v_cvt_pk_bf16_f32 v60, v60, v61
    v_lshlrev_b32 v61, 16, v60
    v_and_b32 v60, 0xffff0000, v60
    v_add_f32 v14, v14, v61
    v_add_f32 v14, v14, v60
    v_lshlrev_b32 v60, 16, v43
    v_and_b32 v61, 0xffff0000, v43
    v_lshlrev_b32 v62, 16, v51
    v_and_b32 v63, 0xffff0000, v51
    v_mul_f32 v60, v60, v62
    v_mul_f32 v61, v61, v63
    v_cvt_pk_bf16_f32 v60, v60, v61
    v_lshlrev_b32 v61, 16, v60
    v_and_b32 v60, 0xffff0000, v60
    v_add_f32 v14, v14, v61
    v_add_f32 v14, v14, v60
    v_lshlrev_b32 v60, 16, v44
    v_and_b32 v61, 0xffff0000, v44
    v_lshlrev_b32 v62, 16, v52
    v_and_b32 v63, 0xffff0000, v52
    v_mul_f32 v60, v60, v62
    v_mul_f32 v61, v61, v63
    v_cvt_pk_bf16_f32 v60, v60, v61
    v_lshlrev_b32 v61, 16, v60
    v_and_b32 v60, 0xffff0000, v60
    v_add_f32 v14, v14, v61
    v_add_f32 v14, v14, v60
    v_lshlrev_b32 v60, 16, v45
    v_and_b32 v61, 0xffff0000, v45
    v_lshlrev_b32 v62, 16, v53
    v_and_b32 v63, 0xffff0000, v53
    v_mul_f32 v60, v60, v62
    v_mul_f32 v61, v61, v63
    v_cvt_pk_bf16_f32 v60, v60, v61
    v_lshlrev_b32 v61, 16, v60
    v_and_b32 v60, 0xffff0000, v60
    v_add_f32 v14, v14, v61
    v_add_f32 v14, v14, v60
    v_lshlrev_b32 v60, 16, v46
    v_and_b32 v61, 0xffff0000, v46
    v_lshlrev_b32 v62, 16, v54
    v_and_b32 v63, 0xffff0000, v54
    v_mul_f32 v60, v60, v62
    v_mul_f32 v61, v61, v63
    v_cvt_pk_bf16_f32 v60, v60, v61
    v_lshlrev_b32 v61, 16, v60
    v_and_b32 v60, 0xffff0000, v60
    v_add_f32 v14, v14, v61
    v_add_f32 v14, v14, v60
    v_lshlrev_b32 v60, 16, v47
    v_and_b32 v61, 0xffff0000, v47
    v_lshlrev_b32 v62, 16, v55
    v_and_b32 v63, 0xffff0000, v55
    v_mul_f32 v60, v60, v62
    v_mul_f32 v61, v61, v63
    v_cvt_pk_bf16_f32 v60, v60, v61
    v_lshlrev_b32 v61, 16, v60
    v_and_b32 v60, 0xffff0000, v60
    v_add_f32 v14, v14, v61
    v_add_f32 v14, v14, v60
    ds_swizzle_b32 v15, v14 offset:1055
    s_waitcnt lgkmcnt(0)
    v_add_f32 v14, v14, v15
    ds_swizzle_b32 v15, v14 offset:2079
    s_waitcnt lgkmcnt(0)
    v_add_f32 v14, v14, v15
    ds_swizzle_b32 v15, v14 offset:4127
    s_waitcnt lgkmcnt(0)
    v_add_f32 v14, v14, v15
    ds_swizzle_b32 v15, v14 offset:8223
    s_waitcnt lgkmcnt(0)
    v_add_f32 v14, v14, v15
    ds_swizzle_b32 v15, v14 offset:16415
    s_waitcnt lgkmcnt(0)
    v_add_f32 v14, v14, v15
    v_cvt_pk_bf16_f32 v14, v14, v14
    v_lshlrev_b32 v14, 16, v14
    v_mul_f32 v14, 0xbfb8aa3b, v14
    v_exp_f32 v14, v14
    s_nop 0
    v_add_f32 v14, 1.0, v14
    v_rcp_f32 v14, v14
    s_nop 0
    v_cvt_pk_bf16_f32 v14, v14, v14
    v_lshlrev_b32 v14, 16, v14
    s_lshl_b32 s52, s3, 7
    v_add_u32 v10, s52, v10
    v_lshlrev_b32 v10, 2, v10
    v_add_u32 v10, 13631488, v10
    buffer_store_dword v14, v10, s[20:23], 0 offen
    s_lshl_b32 s7, s4, 16
    v_and_b32 v20, 0xffff, v7
    v_add_u32 v20, s7, v20
    v_add_u32 v21, 8192, v20
    s_cmp_lt_u32 s5, 4
    s_cselect_b32 s12, s12, s16
    s_cselect_b32 s13, s13, s17
    s_lshl_b32 s51, s50, 6
    v_add_u32 v13, s51, v3
    s_lshl_b32 s51, s61, 2
    v_add_u32 v12, s51, v4
    v_and_b32 v14, 7, v3
    v_xor_b32 v12, v12, v14
    v_lshlrev_b32 v30, 7, v13
    v_lshl_add_u32 v30, v12, 4, v30
    v_add_u32 v30, 16384, v30
    v_add_u32 v31, 90112, v30
    v_accvgpr_write_b32 a0, 0
    v_accvgpr_write_b32 a1, 0
    v_accvgpr_write_b32 a2, 0
    v_accvgpr_write_b32 a3, 0
    v_accvgpr_write_b32 a4, 0
    v_accvgpr_write_b32 a5, 0
    v_accvgpr_write_b32 a6, 0
    v_accvgpr_write_b32 a7, 0
    v_accvgpr_write_b32 a8, 0
    v_accvgpr_write_b32 a9, 0
    v_accvgpr_write_b32 a10, 0
    v_accvgpr_write_b32 a11, 0
    v_accvgpr_write_b32 a12, 0
    v_accvgpr_write_b32 a13, 0
    v_accvgpr_write_b32 a14, 0
    v_accvgpr_write_b32 a15, 0
    v_accvgpr_write_b32 a16, 0
    v_accvgpr_write_b32 a17, 0
    v_accvgpr_write_b32 a18, 0
    v_accvgpr_write_b32 a19, 0
    v_accvgpr_write_b32 a20, 0
    v_accvgpr_write_b32 a21, 0
    v_accvgpr_write_b32 a22, 0
    v_accvgpr_write_b32 a23, 0
    v_accvgpr_write_b32 a24, 0
    v_accvgpr_write_b32 a25, 0
    v_accvgpr_write_b32 a26, 0
    v_accvgpr_write_b32 a27, 0
    v_accvgpr_write_b32 a28, 0
    v_accvgpr_write_b32 a29, 0
    v_accvgpr_write_b32 a30, 0
    v_accvgpr_write_b32 a31, 0
    v_accvgpr_write_b32 a32, 0
    v_accvgpr_write_b32 a33, 0
    v_accvgpr_write_b32 a34, 0
    v_accvgpr_write_b32 a35, 0
    v_accvgpr_write_b32 a36, 0
    v_accvgpr_write_b32 a37, 0
    v_accvgpr_write_b32 a38, 0
    v_accvgpr_write_b32 a39, 0
    v_accvgpr_write_b32 a40, 0
    v_accvgpr_write_b32 a41, 0
    v_accvgpr_write_b32 a42, 0
    v_accvgpr_write_b32 a43, 0
    v_accvgpr_write_b32 a44, 0
    v_accvgpr_write_b32 a45, 0
    v_accvgpr_write_b32 a46, 0
    v_accvgpr_write_b32 a47, 0
    v_accvgpr_write_b32 a48, 0
    v_accvgpr_write_b32 a49, 0
    v_accvgpr_write_b32 a50, 0
    v_accvgpr_write_b32 a51, 0
    v_accvgpr_write_b32 a52, 0
    v_accvgpr_write_b32 a53, 0
    v_accvgpr_write_b32 a54, 0
    v_accvgpr_write_b32 a55, 0
    v_accvgpr_write_b32 a56, 0
    v_accvgpr_write_b32 a57, 0
    v_accvgpr_write_b32 a58, 0
    v_accvgpr_write_b32 a59, 0
    v_accvgpr_write_b32 a60, 0
    v_accvgpr_write_b32 a61, 0
    v_accvgpr_write_b32 a62, 0
    v_accvgpr_write_b32 a63, 0
    s_mov_b32 s46, 0
    s_add_u32 s59, s58, 0
    s_mov_b32 m0, s59
    s_nop 0
    buffer_load_dwordx4 v5, s[8:11], s46 offen lds
    s_add_u32 s59, s58, 1024
    s_mov_b32 m0, s59
    s_nop 0
    buffer_load_dwordx4 v6, s[8:11], s46 offen lds
    s_add_u32 s59, s58, 16384
    s_mov_b32 m0, s59
    s_nop 0
    buffer_load_dwordx4 v20, s[12:15], s46 offen lds
    s_add_u32 s59, s58, 17408
    s_mov_b32 m0, s59
    s_nop 0
    buffer_load_dwordx4 v21, s[12:15], s46 offen lds
    s_mov_b32 s46, 128
    s_add_u32 s59, s58, 45056
    s_mov_b32 m0, s59
    s_nop 0
    buffer_load_dwordx4 v5, s[8:11], s46 offen lds
    s_add_u32 s59, s58, 46080
    s_mov_b32 m0, s59
    s_nop 0
    buffer_load_dwordx4 v6, s[8:11], s46 offen lds
    s_add_u32 s59, s58, 61440
    s_mov_b32 m0, s59
    s_nop 0
    buffer_load_dwordx4 v20, s[12:15], s46 offen lds
    s_add_u32 s59, s58, 62464
    s_mov_b32 m0, s59
    s_nop 0
    buffer_load_dwordx4 v21, s[12:15], s46 offen lds
    s_waitcnt vmcnt(4)
    s_barrier
    ds_read_b128 v[40:43], v28 offset:0
    ds_read_b128 v[44:47], v28 offset:2048
    ds_read_b128 v[48:51], v28 offset:4096
    ds_read_b128 v[52:55], v28 offset:6144
    ds_read_b128 v[56:59], v30 offset:0
    ds_read_b128 v[60:63], v30 offset:2048
    ds_read_b128 v[64:67], v30 offset:4096
    ds_read_b128 v[68:71], v30 offset:6144
    s_mov_b32 s46, 256
    s_add_u32 s59, s58, 90112
    s_mov_b32 m0, s59
    s_nop 0
    buffer_load_dwordx4 v5, s[8:11], s46 offen lds
    s_add_u32 s59, s58, 91136
    s_mov_b32 m0, s59
    s_nop 0
    buffer_load_dwordx4 v6, s[8:11], s46 offen lds
    s_add_u32 s59, s58, 106496
    s_mov_b32 m0, s59
    s_nop 0
    buffer_load_dwordx4 v20, s[12:15], s46 offen lds
    s_add_u32 s59, s58, 107520
    s_mov_b32 m0, s59
    s_nop 0
    buffer_load_dwordx4 v21, s[12:15], s46 offen lds
    s_waitcnt lgkmcnt(3)
    v_mfma_f32_16x16x32_bf16 a[0:3], v[40:43], v[56:59], a[0:3]
    v_mfma_f32_16x16x32_bf16 a[4:7], v[44:47], v[56:59], a[4:7]
    v_mfma_f32_16x16x32_bf16 a[8:11], v[48:51], v[56:59], a[8:11]
    v_mfma_f32_16x16x32_bf16 a[12:15], v[52:55], v[56:59], a[12:15]
    s_waitcnt lgkmcnt(2)
    v_mfma_f32_16x16x32_bf16 a[16:19], v[40:43], v[60:63], a[16:19]
    v_mfma_f32_16x16x32_bf16 a[20:23], v[44:47], v[60:63], a[20:23]
    v_mfma_f32_16x16x32_bf16 a[24:27], v[48:51], v[60:63], a[24:27]
    v_mfma_f32_16x16x32_bf16 a[28:31], v[52:55], v[60:63], a[28:31]
    s_waitcnt lgkmcnt(1)
    v_mfma_f32_16x16x32_bf16 a[32:35], v[40:43], v[64:67], a[32:35]
    v_mfma_f32_16x16x32_bf16 a[36:39], v[44:47], v[64:67], a[36:39]
    v_mfma_f32_16x16x32_bf16 a[40:43], v[48:51], v[64:67], a[40:43]
    v_mfma_f32_16x16x32_bf16 a[44:47], v[52:55], v[64:67], a[44:47]
    s_waitcnt lgkmcnt(0)
    v_mfma_f32_16x16x32_bf16 a[48:51], v[40:43], v[68:71], a[48:51]
    v_mfma_f32_16x16x32_bf16 a[52:55], v[44:47], v[68:71], a[52:55]
    v_mfma_f32_16x16x32_bf16 a[56:59], v[48:51], v[68:71], a[56:59]
    v_mfma_f32_16x16x32_bf16 a[60:63], v[52:55], v[68:71], a[60:63]
    s_waitcnt vmcnt(4)
    s_barrier
    ds_read_b128 v[40:43], v28 offset:45056
    ds_read_b128 v[44:47], v28 offset:47104
    ds_read_b128 v[48:51], v28 offset:49152
    ds_read_b128 v[52:55], v28 offset:51200
    ds_read_b128 v[56:59], v30 offset:45056
    ds_read_b128 v[60:63], v30 offset:47104
    ds_read_b128 v[64:67], v30 offset:49152
    ds_read_b128 v[68:71], v30 offset:51200
    s_mov_b32 s46, 384
    s_add_u32 s59, s58, 0
    s_mov_b32 m0, s59
    s_nop 0
    buffer_load_dwordx4 v5, s[8:11], s46 offen lds
    s_add_u32 s59, s58, 1024
    s_mov_b32 m0, s59
    s_nop 0
    buffer_load_dwordx4 v6, s[8:11], s46 offen lds
    s_add_u32 s59, s58, 16384
    s_mov_b32 m0, s59
    s_nop 0
    buffer_load_dwordx4 v20, s[12:15], s46 offen lds
    s_add_u32 s59, s58, 17408
    s_mov_b32 m0, s59
    s_nop 0
    buffer_load_dwordx4 v21, s[12:15], s46 offen lds
    s_waitcnt lgkmcnt(3)
    v_mfma_f32_16x16x32_bf16 a[0:3], v[40:43], v[56:59], a[0:3]
    v_mfma_f32_16x16x32_bf16 a[4:7], v[44:47], v[56:59], a[4:7]
    v_mfma_f32_16x16x32_bf16 a[8:11], v[48:51], v[56:59], a[8:11]
    v_mfma_f32_16x16x32_bf16 a[12:15], v[52:55], v[56:59], a[12:15]
    s_waitcnt lgkmcnt(2)
    v_mfma_f32_16x16x32_bf16 a[16:19], v[40:43], v[60:63], a[16:19]
    v_mfma_f32_16x16x32_bf16 a[20:23], v[44:47], v[60:63], a[20:23]
    v_mfma_f32_16x16x32_bf16 a[24:27], v[48:51], v[60:63], a[24:27]
    v_mfma_f32_16x16x32_bf16 a[28:31], v[52:55], v[60:63], a[28:31]
    s_waitcnt lgkmcnt(1)
    v_mfma_f32_16x16x32_bf16 a[32:35], v[40:43], v[64:67], a[32:35]
    v_mfma_f32_16x16x32_bf16 a[36:39], v[44:47], v[64:67], a[36:39]
    v_mfma_f32_16x16x32_bf16 a[40:43], v[48:51], v[64:67], a[40:43]
    v_mfma_f32_16x16x32_bf16 a[44:47], v[52:55], v[64:67], a[44:47]
    s_waitcnt lgkmcnt(0)
    v_mfma_f32_16x16x32_bf16 a[48:51], v[40:43], v[68:71], a[48:51]
    v_mfma_f32_16x16x32_bf16 a[52:55], v[44:47], v[68:71], a[52:55]
    v_mfma_f32_16x16x32_bf16 a[56:59], v[48:51], v[68:71], a[56:59]
    v_mfma_f32_16x16x32_bf16 a[60:63], v[52:55], v[68:71], a[60:63]
    s_waitcnt vmcnt(4)
    s_barrier
    ds_read_b128 v[40:43], v29 offset:0
    ds_read_b128 v[44:47], v29 offset:2048
    ds_read_b128 v[48:51], v29 offset:4096
    ds_read_b128 v[52:55], v29 offset:6144
    ds_read_b128 v[56:59], v31 offset:0
    ds_read_b128 v[60:63], v31 offset:2048
    ds_read_b128 v[64:67], v31 offset:4096
    ds_read_b128 v[68:71], v31 offset:6144
    s_mov_b32 s46, 512
    s_add_u32 s59, s58, 45056
    s_mov_b32 m0, s59
    s_nop 0
    buffer_load_dwordx4 v5, s[8:11], s46 offen lds
    s_add_u32 s59, s58, 46080
    s_mov_b32 m0, s59
    s_nop 0
    buffer_load_dwordx4 v6, s[8:11], s46 offen lds
    s_add_u32 s59, s58, 61440
    s_mov_b32 m0, s59
    s_nop 0
    buffer_load_dwordx4 v20, s[12:15], s46 offen lds
    s_add_u32 s59, s58, 62464
    s_mov_b32 m0, s59
    s_nop 0
    buffer_load_dwordx4 v21, s[12:15], s46 offen lds
    s_waitcnt lgkmcnt(3)
    v_mfma_f32_16x16x32_bf16 a[0:3], v[40:43], v[56:59], a[0:3]
    v_mfma_f32_16x16x32_bf16 a[4:7], v[44:47], v[56:59], a[4:7]
    v_mfma_f32_16x16x32_bf16 a[8:11], v[48:51], v[56:59], a[8:11]
    v_mfma_f32_16x16x32_bf16 a[12:15], v[52:55], v[56:59], a[12:15]
    s_waitcnt lgkmcnt(2)
    v_mfma_f32_16x16x32_bf16 a[16:19], v[40:43], v[60:63], a[16:19]
    v_mfma_f32_16x16x32_bf16 a[20:23], v[44:47], v[60:63], a[20:23]
    v_mfma_f32_16x16x32_bf16 a[24:27], v[48:51], v[60:63], a[24:27]
    v_mfma_f32_16x16x32_bf16 a[28:31], v[52:55], v[60:63], a[28:31]
    s_waitcnt lgkmcnt(1)
    v_mfma_f32_16x16x32_bf16 a[32:35], v[40:43], v[64:67], a[32:35]
    v_mfma_f32_16x16x32_bf16 a[36:39], v[44:47], v[64:67], a[36:39]
    v_mfma_f32_16x16x32_bf16 a[40:43], v[48:51], v[64:67], a[40:43]
    v_mfma_f32_16x16x32_bf16 a[44:47], v[52:55], v[64:67], a[44:47]
    s_waitcnt lgkmcnt(0)
    v_mfma_f32_16x16x32_bf16 a[48:51], v[40:43], v[68:71], a[48:51]
    v_mfma_f32_16x16x32_bf16 a[52:55], v[44:47], v[68:71], a[52:55]
    v_mfma_f32_16x16x32_bf16 a[56:59], v[48:51], v[68:71], a[56:59]
    v_mfma_f32_16x16x32_bf16 a[60:63], v[52:55], v[68:71], a[60:63]
    s_waitcnt vmcnt(4)
    s_barrier
    ds_read_b128 v[40:43], v28 offset:0
    ds_read_b128 v[44:47], v28 offset:2048
    ds_read_b128 v[48:51], v28 offset:4096
    ds_read_b128 v[52:55], v28 offset:6144
    ds_read_b128 v[56:59], v30 offset:0
    ds_read_b128 v[60:63], v30 offset:2048
    ds_read_b128 v[64:67], v30 offset:4096
    ds_read_b128 v[68:71], v30 offset:6144
    s_mov_b32 s46, 640
    s_add_u32 s59, s58, 90112
    s_mov_b32 m0, s59
    s_nop 0
    buffer_load_dwordx4 v5, s[8:11], s46 offen lds
    s_add_u32 s59, s58, 91136
    s_mov_b32 m0, s59
    s_nop 0
    buffer_load_dwordx4 v6, s[8:11], s46 offen lds
    s_add_u32 s59, s58, 106496
    s_mov_b32 m0, s59
    s_nop 0
    buffer_load_dwordx4 v20, s[12:15], s46 offen lds
    s_add_u32 s59, s58, 107520
    s_mov_b32 m0, s59
    s_nop 0
    buffer_load_dwordx4 v21, s[12:15], s46 offen lds
    s_waitcnt lgkmcnt(3)
    v_mfma_f32_16x16x32_bf16 a[0:3], v[40:43], v[56:59], a[0:3]
    v_mfma_f32_16x16x32_bf16 a[4:7], v[44:47], v[56:59], a[4:7]
    v_mfma_f32_16x16x32_bf16 a[8:11], v[48:51], v[56:59], a[8:11]
    v_mfma_f32_16x16x32_bf16 a[12:15], v[52:55], v[56:59], a[12:15]
    s_waitcnt lgkmcnt(2)
    v_mfma_f32_16x16x32_bf16 a[16:19], v[40:43], v[60:63], a[16:19]
    v_mfma_f32_16x16x32_bf16 a[20:23], v[44:47], v[60:63], a[20:23]
    v_mfma_f32_16x16x32_bf16 a[24:27], v[48:51], v[60:63], a[24:27]
    v_mfma_f32_16x16x32_bf16 a[28:31], v[52:55], v[60:63], a[28:31]
    s_waitcnt lgkmcnt(1)
    v_mfma_f32_16x16x32_bf16 a[32:35], v[40:43], v[64:67], a[32:35]
    v_mfma_f32_16x16x32_bf16 a[36:39], v[44:47], v[64:67], a[36:39]
    v_mfma_f32_16x16x32_bf16 a[40:43], v[48:51], v[64:67], a[40:43]
    v_mfma_f32_16x16x32_bf16 a[44:47], v[52:55], v[64:67], a[44:47]
    s_waitcnt lgkmcnt(0)
    v_mfma_f32_16x16x32_bf16 a[48:51], v[40:43], v[68:71], a[48:51]
    v_mfma_f32_16x16x32_bf16 a[52:55], v[44:47], v[68:71], a[52:55]
    v_mfma_f32_16x16x32_bf16 a[56:59], v[48:51], v[68:71], a[56:59]
    v_mfma_f32_16x16x32_bf16 a[60:63], v[52:55], v[68:71], a[60:63]
    s_waitcnt vmcnt(4)
    s_barrier
    ds_read_b128 v[40:43], v28 offset:45056
    ds_read_b128 v[44:47], v28 offset:47104
    ds_read_b128 v[48:51], v28 offset:49152
    ds_read_b128 v[52:55], v28 offset:51200
    ds_read_b128 v[56:59], v30 offset:45056
    ds_read_b128 v[60:63], v30 offset:47104
    ds_read_b128 v[64:67], v30 offset:49152
    ds_read_b128 v[68:71], v30 offset:51200
    s_mov_b32 s46, 768
    s_add_u32 s59, s58, 0
    s_mov_b32 m0, s59
    s_nop 0
    buffer_load_dwordx4 v5, s[8:11], s46 offen lds
    s_add_u32 s59, s58, 1024
    s_mov_b32 m0, s59
    s_nop 0
    buffer_load_dwordx4 v6, s[8:11], s46 offen lds
    s_add_u32 s59, s58, 16384
    s_mov_b32 m0, s59
    s_nop 0
    buffer_load_dwordx4 v20, s[12:15], s46 offen lds
    s_add_u32 s59, s58, 17408
    s_mov_b32 m0, s59
    s_nop 0
    buffer_load_dwordx4 v21, s[12:15], s46 offen lds
    s_waitcnt lgkmcnt(3)
    v_mfma_f32_16x16x32_bf16 a[0:3], v[40:43], v[56:59], a[0:3]
    v_mfma_f32_16x16x32_bf16 a[4:7], v[44:47], v[56:59], a[4:7]
    v_mfma_f32_16x16x32_bf16 a[8:11], v[48:51], v[56:59], a[8:11]
    v_mfma_f32_16x16x32_bf16 a[12:15], v[52:55], v[56:59], a[12:15]
    s_waitcnt lgkmcnt(2)
    v_mfma_f32_16x16x32_bf16 a[16:19], v[40:43], v[60:63], a[16:19]
    v_mfma_f32_16x16x32_bf16 a[20:23], v[44:47], v[60:63], a[20:23]
    v_mfma_f32_16x16x32_bf16 a[24:27], v[48:51], v[60:63], a[24:27]
    v_mfma_f32_16x16x32_bf16 a[28:31], v[52:55], v[60:63], a[28:31]
    s_waitcnt lgkmcnt(1)
    v_mfma_f32_16x16x32_bf16 a[32:35], v[40:43], v[64:67], a[32:35]
    v_mfma_f32_16x16x32_bf16 a[36:39], v[44:47], v[64:67], a[36:39]
    v_mfma_f32_16x16x32_bf16 a[40:43], v[48:51], v[64:67], a[40:43]
    v_mfma_f32_16x16x32_bf16 a[44:47], v[52:55], v[64:67], a[44:47]
    s_waitcnt lgkmcnt(0)
    v_mfma_f32_16x16x32_bf16 a[48:51], v[40:43], v[68:71], a[48:51]
    v_mfma_f32_16x16x32_bf16 a[52:55], v[44:47], v[68:71], a[52:55]
    v_mfma_f32_16x16x32_bf16 a[56:59], v[48:51], v[68:71], a[56:59]
    v_mfma_f32_16x16x32_bf16 a[60:63], v[52:55], v[68:71], a[60:63]
    s_waitcnt vmcnt(4)
    s_barrier
    ds_read_b128 v[40:43], v29 offset:0
    ds_read_b128 v[44:47], v29 offset:2048
    ds_read_b128 v[48:51], v29 offset:4096
    ds_read_b128 v[52:55], v29 offset:6144
    ds_read_b128 v[56:59], v31 offset:0
    ds_read_b128 v[60:63], v31 offset:2048
    ds_read_b128 v[64:67], v31 offset:4096
    ds_read_b128 v[68:71], v31 offset:6144
    s_mov_b32 s46, 896
    s_add_u32 s59, s58, 45056
    s_mov_b32 m0, s59
    s_nop 0
    buffer_load_dwordx4 v5, s[8:11], s46 offen lds
    s_add_u32 s59, s58, 46080
    s_mov_b32 m0, s59
    s_nop 0
    buffer_load_dwordx4 v6, s[8:11], s46 offen lds
    s_add_u32 s59, s58, 61440
    s_mov_b32 m0, s59
    s_nop 0
    buffer_load_dwordx4 v20, s[12:15], s46 offen lds
    s_add_u32 s59, s58, 62464
    s_mov_b32 m0, s59
    s_nop 0
    buffer_load_dwordx4 v21, s[12:15], s46 offen lds
    s_waitcnt lgkmcnt(3)
    v_mfma_f32_16x16x32_bf16 a[0:3], v[40:43], v[56:59], a[0:3]
    v_mfma_f32_16x16x32_bf16 a[4:7], v[44:47], v[56:59], a[4:7]
    v_mfma_f32_16x16x32_bf16 a[8:11], v[48:51], v[56:59], a[8:11]
    v_mfma_f32_16x16x32_bf16 a[12:15], v[52:55], v[56:59], a[12:15]
    s_waitcnt lgkmcnt(2)
    v_mfma_f32_16x16x32_bf16 a[16:19], v[40:43], v[60:63], a[16:19]
    v_mfma_f32_16x16x32_bf16 a[20:23], v[44:47], v[60:63], a[20:23]
    v_mfma_f32_16x16x32_bf16 a[24:27], v[48:51], v[60:63], a[24:27]
    v_mfma_f32_16x16x32_bf16 a[28:31], v[52:55], v[60:63], a[28:31]
    s_waitcnt lgkmcnt(1)
    v_mfma_f32_16x16x32_bf16 a[32:35], v[40:43], v[64:67], a[32:35]
    v_mfma_f32_16x16x32_bf16 a[36:39], v[44:47], v[64:67], a[36:39]
    v_mfma_f32_16x16x32_bf16 a[40:43], v[48:51], v[64:67], a[40:43]
    v_mfma_f32_16x16x32_bf16 a[44:47], v[52:55], v[64:67], a[44:47]
    s_waitcnt lgkmcnt(0)
    v_mfma_f32_16x16x32_bf16 a[48:51], v[40:43], v[68:71], a[48:51]
    v_mfma_f32_16x16x32_bf16 a[52:55], v[44:47], v[68:71], a[52:55]
    v_mfma_f32_16x16x32_bf16 a[56:59], v[48:51], v[68:71], a[56:59]
    v_mfma_f32_16x16x32_bf16 a[60:63], v[52:55], v[68:71], a[60:63]
    s_waitcnt vmcnt(4)
    s_barrier
    ds_read_b128 v[40:43], v28 offset:0
    ds_read_b128 v[44:47], v28 offset:2048
    ds_read_b128 v[48:51], v28 offset:4096
    ds_read_b128 v[52:55], v28 offset:6144
    ds_read_b128 v[56:59], v30 offset:0
    ds_read_b128 v[60:63], v30 offset:2048
    ds_read_b128 v[64:67], v30 offset:4096
    ds_read_b128 v[68:71], v30 offset:6144
    s_waitcnt lgkmcnt(3)
    v_mfma_f32_16x16x32_bf16 a[0:3], v[40:43], v[56:59], a[0:3]
    v_mfma_f32_16x16x32_bf16 a[4:7], v[44:47], v[56:59], a[4:7]
    v_mfma_f32_16x16x32_bf16 a[8:11], v[48:51], v[56:59], a[8:11]
    v_mfma_f32_16x16x32_bf16 a[12:15], v[52:55], v[56:59], a[12:15]
    s_waitcnt lgkmcnt(2)
    v_mfma_f32_16x16x32_bf16 a[16:19], v[40:43], v[60:63], a[16:19]
    v_mfma_f32_16x16x32_bf16 a[20:23], v[44:47], v[60:63], a[20:23]
    v_mfma_f32_16x16x32_bf16 a[24:27], v[48:51], v[60:63], a[24:27]
    v_mfma_f32_16x16x32_bf16 a[28:31], v[52:55], v[60:63], a[28:31]
    s_waitcnt lgkmcnt(1)
    v_mfma_f32_16x16x32_bf16 a[32:35], v[40:43], v[64:67], a[32:35]
    v_mfma_f32_16x16x32_bf16 a[36:39], v[44:47], v[64:67], a[36:39]
    v_mfma_f32_16x16x32_bf16 a[40:43], v[48:51], v[64:67], a[40:43]
    v_mfma_f32_16x16x32_bf16 a[44:47], v[52:55], v[64:67], a[44:47]
    s_waitcnt lgkmcnt(0)
    v_mfma_f32_16x16x32_bf16 a[48:51], v[40:43], v[68:71], a[48:51]
    v_mfma_f32_16x16x32_bf16 a[52:55], v[44:47], v[68:71], a[52:55]
    v_mfma_f32_16x16x32_bf16 a[56:59], v[48:51], v[68:71], a[56:59]
    v_mfma_f32_16x16x32_bf16 a[60:63], v[52:55], v[68:71], a[60:63]
    s_waitcnt vmcnt(0)
    s_barrier
    ds_read_b128 v[40:43], v28 offset:45056
    ds_read_b128 v[44:47], v28 offset:47104
    ds_read_b128 v[48:51], v28 offset:49152
    ds_read_b128 v[52:55], v28 offset:51200
    ds_read_b128 v[56:59], v30 offset:45056
    ds_read_b128 v[60:63], v30 offset:47104
    ds_read_b128 v[64:67], v30 offset:49152
    ds_read_b128 v[68:71], v30 offset:51200
    s_waitcnt lgkmcnt(3)
    v_mfma_f32_16x16x32_bf16 a[0:3], v[40:43], v[56:59], a[0:3]
    v_mfma_f32_16x16x32_bf16 a[4:7], v[44:47], v[56:59], a[4:7]
    v_mfma_f32_16x16x32_bf16 a[8:11], v[48:51], v[56:59], a[8:11]
    v_mfma_f32_16x16x32_bf16 a[12:15], v[52:55], v[56:59], a[12:15]
    s_waitcnt lgkmcnt(2)
    v_mfma_f32_16x16x32_bf16 a[16:19], v[40:43], v[60:63], a[16:19]
    v_mfma_f32_16x16x32_bf16 a[20:23], v[44:47], v[60:63], a[20:23]
    v_mfma_f32_16x16x32_bf16 a[24:27], v[48:51], v[60:63], a[24:27]
    v_mfma_f32_16x16x32_bf16 a[28:31], v[52:55], v[60:63], a[28:31]
    s_waitcnt lgkmcnt(1)
    v_mfma_f32_16x16x32_bf16 a[32:35], v[40:43], v[64:67], a[32:35]
    v_mfma_f32_16x16x32_bf16 a[36:39], v[44:47], v[64:67], a[36:39]
    v_mfma_f32_16x16x32_bf16 a[40:43], v[48:51], v[64:67], a[40:43]
    v_mfma_f32_16x16x32_bf16 a[44:47], v[52:55], v[64:67], a[44:47]
    s_waitcnt lgkmcnt(0)
    v_mfma_f32_16x16x32_bf16 a[48:51], v[40:43], v[68:71], a[48:51]
    v_mfma_f32_16x16x32_bf16 a[52:55], v[44:47], v[68:71], a[52:55]
    v_mfma_f32_16x16x32_bf16 a[56:59], v[48:51], v[68:71], a[56:59]
    v_mfma_f32_16x16x32_bf16 a[60:63], v[52:55], v[68:71], a[60:63]
    s_barrier
    s_lshl_b32 s51, s49, 6
    v_lshl_add_u32 v10, v4, 2, s51
    v_mul_u32_u24 v10, 528, v10
    s_lshl_b32 s51, s50, 8
    v_lshl_add_u32 v11, v3, 2, s51
    v_add_u32 v10, v10, v11
    s_nop 7
    v_lshlrev_b32 v11, 4, v2
    s_and_b32 s51, s5, 3
    s_lshl_b32 s51, s51, 14
    s_add_u32 s51, s51, 67584
    v_add_u32 v11, s51, v11
    s_cmp_eq_u32 s61, 0
    s_cbranch_scc1 K1S_W1
    ds_write_b128 v11, a[0:3] offset:0
    ds_write_b128 v11, a[4:7] offset:1024
    ds_write_b128 v11, a[8:11] offset:2048
    ds_write_b128 v11, a[12:15] offset:3072
    ds_write_b128 v11, a[16:19] offset:4096
    ds_write_b128 v11, a[20:23] offset:5120
    ds_write_b128 v11, a[24:27] offset:6144
    ds_write_b128 v11, a[28:31] offset:7168
    ds_write_b128 v11, a[32:35] offset:8192
    ds_write_b128 v11, a[36:39] offset:9216
    ds_write_b128 v11, a[40:43] offset:10240
    ds_write_b128 v11, a[44:47] offset:11264
    ds_write_b128 v11, a[48:51] offset:12288
    ds_write_b128 v11, a[52:55] offset:13312
    ds_write_b128 v11, a[56:59] offset:14336
    ds_write_b128 v11, a[60:63] offset:15360
    s_waitcnt lgkmcnt(0)
K1S_W1:
    s_barrier
    s_cmp_eq_u32 s61, 0
    s_cbranch_scc0 K1S_W2
    ds_read_b128 v[60:63], v11 offset:0
    ds_read_b128 v[64:67], v11 offset:1024
    ds_read_b128 v[68:71], v11 offset:2048
    ds_read_b128 v[72:75], v11 offset:3072
    ds_read_b128 v[76:79], v11 offset:4096
    ds_read_b128 v[80:83], v11 offset:5120
    ds_read_b128 v[84:87], v11 offset:6144
    ds_read_b128 v[88:91], v11 offset:7168
    ds_read_b128 v[92:95], v11 offset:8192
    ds_read_b128 v[96:99], v11 offset:9216
    ds_read_b128 v[100:103], v11 offset:10240
    ds_read_b128 v[104:107], v11 offset:11264
    ds_read_b128 v[108:111], v11 offset:12288
    ds_read_b128 v[112:115], v11 offset:13312
    ds_read_b128 v[116:119], v11 offset:14336
    ds_read_b128 v[120:123], v11 offset:15360
    s_waitcnt lgkmcnt(0)
    v_accvgpr_read_b32 v12, a0
    v_add_f32 v12, v12, v60
    ds_write_b32 v10, v12 offset:0
    v_accvgpr_read_b32 v12, a1
    v_add_f32 v12, v12, v61
    ds_write_b32 v10, v12 offset:528
    v_accvgpr_read_b32 v12, a2
    v_add_f32 v12, v12, v62
    ds_write_b32 v10, v12 offset:1056
    v_accvgpr_read_b32 v12, a3
    v_add_f32 v12, v12, v63
    ds_write_b32 v10, v12 offset:1584
    v_accvgpr_read_b32 v12, a4
    v_add_f32 v12, v12, v64
    ds_write_b32 v10, v12 offset:8448
    v_accvgpr_read_b32 v12, a5
    v_add_f32 v12, v12, v65
    ds_write_b32 v10, v12 offset:8976
    v_accvgpr_read_b32 v12, a6
    v_add_f32 v12, v12, v66
    ds_write_b32 v10, v12 offset:9504
    v_accvgpr_read_b32 v12, a7
    v_add_f32 v12, v12, v67
    ds_write_b32 v10, v12 offset:10032
    v_accvgpr_read_b32 v12, a8
    v_add_f32 v12, v12, v68
    ds_write_b32 v10, v12 offset:16896
    v_accvgpr_read_b32 v12, a9
    v_add_f32 v12, v12, v69
    ds_write_b32 v10, v12 offset:17424
    v_accvgpr_read_b32 v12, a10
    v_add_f32 v12, v12, v70
    ds_write_b32 v10, v12 offset:17952
    v_accvgpr_read_b32 v12, a11
    v_add_f32 v12, v12, v71
    ds_write_b32 v10, v12 offset:18480
    v_accvgpr_read_b32 v12, a12
    v_add_f32 v12, v12, v72
    ds_write_b32 v10, v12 offset:25344
    v_accvgpr_read_b32 v12, a13
    v_add_f32 v12, v12, v73
    ds_write_b32 v10, v12 offset:25872
    v_accvgpr_read_b32 v12, a14
    v_add_f32 v12, v12, v74
    ds_write_b32 v10, v12 offset:26400
    v_accvgpr_read_b32 v12, a15
    v_add_f32 v12, v12, v75
    ds_write_b32 v10, v12 offset:26928
    v_accvgpr_read_b32 v12, a16
    v_add_f32 v12, v12, v76
    ds_write_b32 v10, v12 offset:64
    v_accvgpr_read_b32 v12, a17
    v_add_f32 v12, v12, v77
    ds_write_b32 v10, v12 offset:592
    v_accvgpr_read_b32 v12, a18
    v_add_f32 v12, v12, v78
    ds_write_b32 v10, v12 offset:1120
    v_accvgpr_read_b32 v12, a19
    v_add_f32 v12, v12, v79
    ds_write_b32 v10, v12 offset:1648
    v_accvgpr_read_b32 v12, a20
    v_add_f32 v12, v12, v80
    ds_write_b32 v10, v12 offset:8512
    v_accvgpr_read_b32 v12, a21
    v_add_f32 v12, v12, v81
    ds_write_b32 v10, v12 offset:9040
    v_accvgpr_read_b32 v12, a22
    v_add_f32 v12, v12, v82
    ds_write_b32 v10, v12 offset:9568
    v_accvgpr_read_b32 v12, a23
    v_add_f32 v12, v12, v83
    ds_write_b32 v10, v12 offset:10096
    v_accvgpr_read_b32 v12, a24
    v_add_f32 v12, v12, v84
    ds_write_b32 v10, v12 offset:16960
    v_accvgpr_read_b32 v12, a25
    v_add_f32 v12, v12, v85
    ds_write_b32 v10, v12 offset:17488
    v_accvgpr_read_b32 v12, a26
    v_add_f32 v12, v12, v86
    ds_write_b32 v10, v12 offset:18016
    v_accvgpr_read_b32 v12, a27
    v_add_f32 v12, v12, v87
    ds_write_b32 v10, v12 offset:18544
    v_accvgpr_read_b32 v12, a28
    v_add_f32 v12, v12, v88
    ds_write_b32 v10, v12 offset:25408
    v_accvgpr_read_b32 v12, a29
    v_add_f32 v12, v12, v89
    ds_write_b32 v10, v12 offset:25936
    v_accvgpr_read_b32 v12, a30
    v_add_f32 v12, v12, v90
    ds_write_b32 v10, v12 offset:26464
    v_accvgpr_read_b32 v12, a31
    v_add_f32 v12, v12, v91
    ds_write_b32 v10, v12 offset:26992
    v_accvgpr_read_b32 v12, a32
    v_add_f32 v12, v12, v92
    ds_write_b32 v10, v12 offset:128
    v_accvgpr_read_b32 v12, a33
    v_add_f32 v12, v12, v93
    ds_write_b32 v10, v12 offset:656
    v_accvgpr_read_b32 v12, a34
    v_add_f32 v12, v12, v94
    ds_write_b32 v10, v12 offset:1184
    v_accvgpr_read_b32 v12, a35
    v_add_f32 v12, v12, v95
    ds_write_b32 v10, v12 offset:1712
    v_accvgpr_read_b32 v12, a36
    v_add_f32 v12, v12, v96
    ds_write_b32 v10, v12 offset:8576
    v_accvgpr_read_b32 v12, a37
    v_add_f32 v12, v12, v97
    ds_write_b32 v10, v12 offset:9104
    v_accvgpr_read_b32 v12, a38
    v_add_f32 v12, v12, v98
    ds_write_b32 v10, v12 offset:9632
    v_accvgpr_read_b32 v12, a39
    v_add_f32 v12, v12, v99
    ds_write_b32 v10, v12 offset:10160
    v_accvgpr_read_b32 v12, a40
    v_add_f32 v12, v12, v100
    ds_write_b32 v10, v12 offset:17024
    v_accvgpr_read_b32 v12, a41
    v_add_f32 v12, v12, v101
    ds_write_b32 v10, v12 offset:17552
    v_accvgpr_read_b32 v12, a42
    v_add_f32 v12, v12, v102
    ds_write_b32 v10, v12 offset:18080
    v_accvgpr_read_b32 v12, a43
    v_add_f32 v12, v12, v103
    ds_write_b32 v10, v12 offset:18608
    v_accvgpr_read_b32 v12, a44
    v_add_f32 v12, v12, v104
    ds_write_b32 v10, v12 offset:25472
    v_accvgpr_read_b32 v12, a45
    v_add_f32 v12, v12, v105
    ds_write_b32 v10, v12 offset:26000
    v_accvgpr_read_b32 v12, a46
    v_add_f32 v12, v12, v106
    ds_write_b32 v10, v12 offset:26528
    v_accvgpr_read_b32 v12, a47
    v_add_f32 v12, v12, v107
    ds_write_b32 v10, v12 offset:27056
    v_accvgpr_read_b32 v12, a48
    v_add_f32 v12, v12, v108
    ds_write_b32 v10, v12 offset:192
    v_accvgpr_read_b32 v12, a49
    v_add_f32 v12, v12, v109
    ds_write_b32 v10, v12 offset:720
    v_accvgpr_read_b32 v12, a50
    v_add_f32 v12, v12, v110
    ds_write_b32 v10, v12 offset:1248
    v_accvgpr_read_b32 v12, a51
    v_add_f32 v12, v12, v111
    ds_write_b32 v10, v12 offset:1776
    v_accvgpr_read_b32 v12, a52
    v_add_f32 v12, v12, v112
    ds_write_b32 v10, v12 offset:8640
    v_accvgpr_read_b32 v12, a53
    v_add_f32 v12, v12, v113
    ds_write_b32 v10, v12 offset:9168
    v_accvgpr_read_b32 v12, a54
    v_add_f32 v12, v12, v114
    ds_write_b32 v10, v12 offset:9696
    v_accvgpr_read_b32 v12, a55
    v_add_f32 v12, v12, v115
    ds_write_b32 v10, v12 offset:10224
    v_accvgpr_read_b32 v12, a56
    v_add_f32 v12, v12, v116
    ds_write_b32 v10, v12 offset:17088
    v_accvgpr_read_b32 v12, a57
    v_add_f32 v12, v12, v117
    ds_write_b32 v10, v12 offset:17616
    v_accvgpr_read_b32 v12, a58
    v_add_f32 v12, v12, v118
    ds_write_b32 v10, v12 offset:18144
    v_accvgpr_read_b32 v12, a59
    v_add_f32 v12, v12, v119
    ds_write_b32 v10, v12 offset:18672
    v_accvgpr_read_b32 v12, a60
    v_add_f32 v12, v12, v120
    ds_write_b32 v10, v12 offset:25536
    v_accvgpr_read_b32 v12, a61
    v_add_f32 v12, v12, v121
    ds_write_b32 v10, v12 offset:26064
    v_accvgpr_read_b32 v12, a62
    v_add_f32 v12, v12, v122
    ds_write_b32 v10, v12 offset:26592
    v_accvgpr_read_b32 v12, a63
    v_add_f32 v12, v12, v123
    ds_write_b32 v10, v12 offset:27120
K1S_W2:
    s_mov_b32 s48, s26
    s_mov_b32 s49, s27
    s_mov_b32 s50, 1024
    s_mov_b32 s51, 0x00020000
    s_mov_b32 s52, s28
    s_mov_b32 s53, s29
    s_mov_b32 s54, 1024
    s_mov_b32 s55, 0x00020000
    s_mov_b32 s56, s34
    s_mov_b32 s57, s35
    s_mov_b32 s58, 1024
    s_mov_b32 s59, 0x00020000
    v_and_b32 v12, 31, v0
    v_lshrrev_b32 v13, 5, v0
    s_lshl_b32 s7, s4, 7
    v_lshl_add_u32 v14, v12, 2, s7
    buffer_load_dword v40, v14, s[48:51], 0 offen
    buffer_load_dword v41, v14, s[52:55], 0 offen
    buffer_load_dword v42, v14, s[56:59], 0 offen
    s_waitcnt vmcnt(0)
    v_lshlrev_b32 v60, 16, v40
    v_lshlrev_b32 v61, 16, v41
    v_lshlrev_b32 v62, 16, v42
    v_mul_f32 v62, 0x3fb8aa3b, v62
    v_exp_f32 v62, v62
    s_nop 0
    v_cvt_pk_bf16_f32 v62, v62, v62
    v_lshlrev_b32 v62, 16, v62
    v_mul_f32 v63, v62, v60
    v_mul_f32 v64, v62, v61
    v_mul_f32 v63, 0x3fb8aa3b, v63
    v_exp_f32 v63, v63
    v_mul_f32 v64, 0.15915494, v64
    v_cos_f32 v65, v64
    v_sin_f32 v66, v64
    s_nop 0
    v_mul_f32 v44, v63, v65
    v_mul_f32 v46, v63, v66
    v_subrev_f32 v65, 1.0, v44
    v_mul_f32 v66, v60, v60
    v_fma_f32 v66, v61, v61, v66
    v_rcp_f32 v66, v66
    v_mul_f32 v67, v65, v60
    v_fma_f32 v67, v46, v61, v67
    v_mul_f32 v68, v46, v60
    v_fma_f32 v68, -v65, v61, v68
    v_mul_f32 v48, v67, v66
    v_mul_f32 v50, v68, v66
    v_and_b32 v60, 0xffff0000, v40
    v_and_b32 v61, 0xffff0000, v41
    v_and_b32 v62, 0xffff0000, v42
    v_mul_f32 v62, 0x3fb8aa3b, v62
    v_exp_f32 v62, v62
    s_nop 0
    v_cvt_pk_bf16_f32 v62, v62, v62
    v_lshlrev_b32 v62, 16, v62
    v_mul_f32 v63, v62, v60
    v_mul_f32 v64, v62, v61
    v_mul_f32 v63, 0x3fb8aa3b, v63
    v_exp_f32 v63, v63
    v_mul_f32 v64, 0.15915494, v64
    v_cos_f32 v65, v64
    v_sin_f32 v66, v64
    s_nop 0
    v_mul_f32 v45, v63, v65
    v_mul_f32 v47, v63, v66
    v_subrev_f32 v65, 1.0, v45
    v_mul_f32 v66, v60, v60
    v_fma_f32 v66, v61, v61, v66
    v_rcp_f32 v66, v66
    v_mul_f32 v67, v65, v60
    v_fma_f32 v67, v47, v61, v67
    v_mul_f32 v68, v47, v60
    v_fma_f32 v68, -v65, v61, v68
    v_mul_f32 v49, v67, v66
    v_mul_f32 v51, v68, v66
    s_waitcnt lgkmcnt(0)
    s_barrier
    v_mul_u32_u24 v15, 4224, v13
    v_lshl_add_u32 v15, v12, 3, v15
    ds_read_b64 v[100:101], v15 offset:0
    ds_read_b64 v[102:103], v15 offset:256
    ds_read_b64 v[104:105], v15 offset:528
    ds_read_b64 v[106:107], v15 offset:784
    ds_read_b64 v[108:109], v15 offset:1056
    ds_read_b64 v[110:111], v15 offset:1312
    ds_read_b64 v[112:113], v15 offset:1584
    ds_read_b64 v[114:115], v15 offset:1840
    ds_read_b64 v[116:117], v15 offset:2112
    ds_read_b64 v[118:119], v15 offset:2368
    ds_read_b64 v[120:121], v15 offset:2640
    ds_read_b64 v[122:123], v15 offset:2896
    ds_read_b64 v[124:125], v15 offset:3168
    ds_read_b64 v[126:127], v15 offset:3424
    ds_read_b64 v[128:129], v15 offset:3696
    ds_read_b64 v[130:131], v15 offset:3952
    s_waitcnt lgkmcnt(0)
    v_fma_f32 v70, v44, v100, v104
    v_fma_f32 v71, v44, v102, v106
    v_fma_f32 v69, -v46, v102, v70
    v_fma_f32 v106, v46, v100, v71
    v_mov_b32 v104, v69
    v_fma_f32 v70, v45, v101, v105
    v_fma_f32 v71, v45, v103, v107
    v_fma_f32 v69, -v47, v103, v70
    v_fma_f32 v107, v47, v101, v71
    v_mov_b32 v105, v69
    v_fma_f32 v70, v44, v104, v108
    v_fma_f32 v71, v44, v106, v110
    v_fma_f32 v69, -v46, v106, v70
    v_fma_f32 v110, v46, v104, v71
    v_mov_b32 v108, v69
    v_fma_f32 v70, v45, v105, v109
    v_fma_f32 v71, v45, v107, v111
    v_fma_f32 v69, -v47, v107, v70
    v_fma_f32 v111, v47, v105, v71
    v_mov_b32 v109, v69
    v_fma_f32 v70, v44, v108, v112
    v_fma_f32 v71, v44, v110, v114
    v_fma_f32 v69, -v46, v110, v70
    v_fma_f32 v114, v46, v108, v71
    v_mov_b32 v112, v69
    v_fma_f32 v70, v45, v109, v113
    v_fma_f32 v71, v45, v111, v115
    v_fma_f32 v69, -v47, v111, v70
    v_fma_f32 v115, v47, v109, v71
    v_mov_b32 v113, v69
    v_fma_f32 v70, v44, v112, v116
    v_fma_f32 v71, v44, v114, v118
    v_fma_f32 v69, -v46, v114, v70
    v_fma_f32 v118, v46, v112, v71
    v_mov_b32 v116, v69
    v_fma_f32 v70, v45, v113, v117
    v_fma_f32 v71, v45, v115, v119
    v_fma_f32 v69, -v47, v115, v70
    v_fma_f32 v119, v47, v113, v71
    v_mov_b32 v117, v69
    v_fma_f32 v70, v44, v116, v120
    v_fma_f32 v71, v44, v118, v122
    v_fma_f32 v69, -v46, v118, v70
    v_fma_f32 v122, v46, v116, v71
    v_mov_b32 v120, v69
    v_fma_f32 v70, v45, v117, v121
    v_fma_f32 v71, v45, v119, v123
    v_fma_f32 v69, -v47, v119, v70
    v_fma_f32 v123, v47, v117, v71
    v_mov_b32 v121, v69
    v_fma_f32 v70, v44, v120, v124
    v_fma_f32 v71, v44, v122, v126
    v_fma_f32 v69, -v46, v122, v70
    v_fma_f32 v126, v46, v120, v71
    v_mov_b32 v124, v69
    v_fma_f32 v70, v45, v121, v125
    v_fma_f32 v71, v45, v123, v127
    v_fma_f32 v69, -v47, v123, v70
    v_fma_f32 v127, v47, v121, v71
    v_mov_b32 v125, v69
    v_fma_f32 v70, v44, v124, v128
    v_fma_f32 v71, v44, v126, v130
    v_fma_f32 v69, -v46, v126, v70
    v_fma_f32 v130, v46, v124, v71
    v_mov_b32 v128, v69
    v_fma_f32 v70, v45, v125, v129
    v_fma_f32 v71, v45, v127, v131
    v_fma_f32 v69, -v47, v127, v70
    v_fma_f32 v131, v47, v125, v71
    v_mov_b32 v129, v69
    v_mov_b32 v52, v44
    v_mov_b32 v54, v46
    v_mul_f32 v70, v52, v52
    v_mul_f32 v71, v52, v54
    v_fma_f32 v52, -v54, v54, v70
    v_add_f32 v54, v71, v71
    v_mul_f32 v70, v52, v52
    v_mul_f32 v71, v52, v54
    v_fma_f32 v52, -v54, v54, v70
    v_add_f32 v54, v71, v71
    v_mul_f32 v70, v52, v52
    v_mul_f32 v71, v52, v54
    v_fma_f32 v52, -v54, v54, v70
    v_add_f32 v54, v71, v71
    v_mov_b32 v53, v45
    v_mov_b32 v55, v47
    v_mul_f32 v70, v53, v53
    v_mul_f32 v71, v53, v55
    v_fma_f32 v53, -v55, v55, v70
    v_add_f32 v55, v71, v71
    v_mul_f32 v70, v53, v53
    v_mul_f32 v71, v53, v55
    v_fma_f32 v53, -v55, v55, v70
    v_add_f32 v55, v71, v71
    v_mul_f32 v70, v53, v53
    v_mul_f32 v71, v53, v55
    v_fma_f32 v53, -v55, v55, v70
    v_add_f32 v55, v71, v71
    v_lshlrev_b32 v16, 4, v0
    v_add_u32 v16, 67584, v16
    ds_write_b128 v16, v[128:131] offset:0
    s_waitcnt lgkmcnt(0)
    s_barrier
    s_cmp_lg_u32 s5, 0
    s_cbranch_scc1 K1_WAITC
    v_lshlrev_b32 v17, 4, v12
    v_add_u32 v97, 67584, v17
    v_mov_b32 v72, 0
    v_mov_b32 v73, 0
    v_mov_b32 v74, 0
    v_mov_b32 v75, 0
    v_mov_b32 v76, 1.0
    v_mov_b32 v77, 1.0
    v_mov_b32 v78, 0
    v_mov_b32 v79, 0
    ds_read_b128 v[80:83], v97 offset:0
    ds_write_b128 v97, v[72:75] offset:8192
    ds_write_b128 v97, v[76:79] offset:16384
    s_waitcnt lgkmcnt(0)
    v_fma_f32 v70, v52, v72, v80
    v_fma_f32 v71, v52, v74, v82
    v_fma_f32 v69, -v54, v74, v70
    v_fma_f32 v74, v54, v72, v71
    v_mov_b32 v72, v69
    v_mul_f32 v84, v76, v52
    v_mul_f32 v85, v76, v54
    v_fma_f32 v76, -v78, v54, v84
    v_fma_f32 v78, v78, v52, v85
    v_fma_f32 v70, v53, v73, v81
    v_fma_f32 v71, v53, v75, v83
    v_fma_f32 v69, -v55, v75, v70
    v_fma_f32 v75, v55, v73, v71
    v_mov_b32 v73, v69
    v_mul_f32 v84, v77, v53
    v_mul_f32 v85, v77, v55
    v_fma_f32 v77, -v79, v55, v84
    v_fma_f32 v79, v79, v53, v85
    ds_read_b128 v[80:83], v97 offset:512
    ds_write_b128 v97, v[72:75] offset:8704
    ds_write_b128 v97, v[76:79] offset:16896
    s_waitcnt lgkmcnt(0)
    v_fma_f32 v70, v52, v72, v80
    v_fma_f32 v71, v52, v74, v82
    v_fma_f32 v69, -v54, v74, v70
    v_fma_f32 v74, v54, v72, v71
    v_mov_b32 v72, v69
    v_mul_f32 v84, v76, v52
    v_mul_f32 v85, v76, v54
    v_fma_f32 v76, -v78, v54, v84
    v_fma_f32 v78, v78, v52, v85
    v_fma_f32 v70, v53, v73, v81
    v_fma_f32 v71, v53, v75, v83
    v_fma_f32 v69, -v55, v75, v70
    v_fma_f32 v75, v55, v73, v71
    v_mov_b32 v73, v69
    v_mul_f32 v84, v77, v53
    v_mul_f32 v85, v77, v55
    v_fma_f32 v77, -v79, v55, v84
    v_fma_f32 v79, v79, v53, v85
    ds_read_b128 v[80:83], v97 offset:1024
    ds_write_b128 v97, v[72:75] offset:9216
    ds_write_b128 v97, v[76:79] offset:17408
    s_waitcnt lgkmcnt(0)
    v_fma_f32 v70, v52, v72, v80
    v_fma_f32 v71, v52, v74, v82
    v_fma_f32 v69, -v54, v74, v70
    v_fma_f32 v74, v54, v72, v71
    v_mov_b32 v72, v69
    v_mul_f32 v84, v76, v52
    v_mul_f32 v85, v76, v54
    v_fma_f32 v76, -v78, v54, v84
    v_fma_f32 v78, v78, v52, v85
    v_fma_f32 v70, v53, v73, v81
    v_fma_f32 v71, v53, v75, v83
    v_fma_f32 v69, -v55, v75, v70
    v_fma_f32 v75, v55, v73, v71
    v_mov_b32 v73, v69
    v_mul_f32 v84, v77, v53
    v_mul_f32 v85, v77, v55
    v_fma_f32 v77, -v79, v55, v84
    v_fma_f32 v79, v79, v53, v85
    ds_read_b128 v[80:83], v97 offset:1536
    ds_write_b128 v97, v[72:75] offset:9728
    ds_write_b128 v97, v[76:79] offset:17920
    s_waitcnt lgkmcnt(0)
    v_fma_f32 v70, v52, v72, v80
    v_fma_f32 v71, v52, v74, v82
    v_fma_f32 v69, -v54, v74, v70
    v_fma_f32 v74, v54, v72, v71
    v_mov_b32 v72, v69
    v_mul_f32 v84, v76, v52
    v_mul_f32 v85, v76, v54
    v_fma_f32 v76, -v78, v54, v84
    v_fma_f32 v78, v78, v52, v85
    v_fma_f32 v70, v53, v73, v81
    v_fma_f32 v71, v53, v75, v83
    v_fma_f32 v69, -v55, v75, v70
    v_fma_f32 v75, v55, v73, v71
    v_mov_b32 v73, v69
    v_mul_f32 v84, v77, v53
    v_mul_f32 v85, v77, v55
    v_fma_f32 v77, -v79, v55, v84
    v_fma_f32 v79, v79, v53, v85
    ds_read_b128 v[80:83], v97 offset:2048
    ds_write_b128 v97, v[72:75] offset:10240
    ds_write_b128 v97, v[76:79] offset:18432
    s_waitcnt lgkmcnt(0)
    v_fma_f32 v70, v52, v72, v80
    v_fma_f32 v71, v52, v74, v82
    v_fma_f32 v69, -v54, v74, v70
    v_fma_f32 v74, v54, v72, v71
    v_mov_b32 v72, v69
    v_mul_f32 v84, v76, v52
    v_mul_f32 v85, v76, v54
    v_fma_f32 v76, -v78, v54, v84
    v_fma_f32 v78, v78, v52, v85
    v_fma_f32 v70, v53, v73, v81
    v_fma_f32 v71, v53, v75, v83
    v_fma_f32 v69, -v55, v75, v70
    v_fma_f32 v75, v55, v73, v71
    v_mov_b32 v73, v69
    v_mul_f32 v84, v77, v53
    v_mul_f32 v85, v77, v55
    v_fma_f32 v77, -v79, v55, v84
    v_fma_f32 v79, v79, v53, v85
    ds_read_b128 v[80:83], v97 offset:2560
    ds_write_b128 v97, v[72:75] offset:10752
    ds_write_b128 v97, v[76:79] offset:18944
    s_waitcnt lgkmcnt(0)
    v_fma_f32 v70, v52, v72, v80
    v_fma_f32 v71, v52, v74, v82
    v_fma_f32 v69, -v54, v74, v70
    v_fma_f32 v74, v54, v72, v71
    v_mov_b32 v72, v69
    v_mul_f32 v84, v76, v52
    v_mul_f32 v85, v76, v54
    v_fma_f32 v76, -v78, v54, v84
    v_fma_f32 v78, v78, v52, v85
    v_fma_f32 v70, v53, v73, v81
    v_fma_f32 v71, v53, v75, v83
    v_fma_f32 v69, -v55, v75, v70
    v_fma_f32 v75, v55, v73, v71
    v_mov_b32 v73, v69
    v_mul_f32 v84, v77, v53
    v_mul_f32 v85, v77, v55
    v_fma_f32 v77, -v79, v55, v84
    v_fma_f32 v79, v79, v53, v85
    ds_read_b128 v[80:83], v97 offset:3072
    ds_write_b128 v97, v[72:75] offset:11264
    ds_write_b128 v97, v[76:79] offset:19456
    s_waitcnt lgkmcnt(0)
    v_fma_f32 v70, v52, v72, v80
    v_fma_f32 v71, v52, v74, v82
    v_fma_f32 v69, -v54, v74, v70
    v_fma_f32 v74, v54, v72, v71
    v_mov_b32 v72, v69
    v_mul_f32 v84, v76, v52
    v_mul_f32 v85, v76, v54
    v_fma_f32 v76, -v78, v54, v84
    v_fma_f32 v78, v78, v52, v85
    v_fma_f32 v70, v53, v73, v81
    v_fma_f32 v71, v53, v75, v83
    v_fma_f32 v69, -v55, v75, v70
    v_fma_f32 v75, v55, v73, v71
    v_mov_b32 v73, v69
    v_mul_f32 v84, v77, v53
    v_mul_f32 v85, v77, v55
    v_fma_f32 v77, -v79, v55, v84
    v_fma_f32 v79, v79, v53, v85
    ds_read_b128 v[80:83], v97 offset:3584
    ds_write_b128 v97, v[72:75] offset:11776
    ds_write_b128 v97, v[76:79] offset:19968
    s_waitcnt lgkmcnt(0)
    v_fma_f32 v70, v52, v72, v80
    v_fma_f32 v71, v52, v74, v82
    v_fma_f32 v69, -v54, v74, v70
    v_fma_f32 v74, v54, v72, v71
    v_mov_b32 v72, v69
    v_mul_f32 v84, v76, v52
    v_mul_f32 v85, v76, v54
    v_fma_f32 v76, -v78, v54, v84
    v_fma_f32 v78, v78, v52, v85
    v_fma_f32 v70, v53, v73, v81
    v_fma_f32 v71, v53, v75, v83
    v_fma_f32 v69, -v55, v75, v70
    v_fma_f32 v75, v55, v73, v71
    v_mov_b32 v73, v69
    v_mul_f32 v84, v77, v53
    v_mul_f32 v85, v77, v55
    v_fma_f32 v77, -v79, v55, v84
    v_fma_f32 v79, v79, v53, v85
    ds_read_b128 v[80:83], v97 offset:4096
    ds_write_b128 v97, v[72:75] offset:12288
    ds_write_b128 v97, v[76:79] offset:20480
    s_waitcnt lgkmcnt(0)
    v_fma_f32 v70, v52, v72, v80
    v_fma_f32 v71, v52, v74, v82
    v_fma_f32 v69, -v54, v74, v70
    v_fma_f32 v74, v54, v72, v71
    v_mov_b32 v72, v69
    v_mul_f32 v84, v76, v52
    v_mul_f32 v85, v76, v54
    v_fma_f32 v76, -v78, v54, v84
    v_fma_f32 v78, v78, v52, v85
    v_fma_f32 v70, v53, v73, v81
    v_fma_f32 v71, v53, v75, v83
    v_fma_f32 v69, -v55, v75, v70
    v_fma_f32 v75, v55, v73, v71
    v_mov_b32 v73, v69
    v_mul_f32 v84, v77, v53
    v_mul_f32 v85, v77, v55
    v_fma_f32 v77, -v79, v55, v84
    v_fma_f32 v79, v79, v53, v85
    ds_read_b128 v[80:83], v97 offset:4608
    ds_write_b128 v97, v[72:75] offset:12800
    ds_write_b128 v97, v[76:79] offset:20992
    s_waitcnt lgkmcnt(0)
    v_fma_f32 v70, v52, v72, v80
    v_fma_f32 v71, v52, v74, v82
    v_fma_f32 v69, -v54, v74, v70
    v_fma_f32 v74, v54, v72, v71
    v_mov_b32 v72, v69
    v_mul_f32 v84, v76, v52
    v_mul_f32 v85, v76, v54
    v_fma_f32 v76, -v78, v54, v84
    v_fma_f32 v78, v78, v52, v85
    v_fma_f32 v70, v53, v73, v81
    v_fma_f32 v71, v53, v75, v83
    v_fma_f32 v69, -v55, v75, v70
    v_fma_f32 v75, v55, v73, v71
    v_mov_b32 v73, v69
    v_mul_f32 v84, v77, v53
    v_mul_f32 v85, v77, v55
    v_fma_f32 v77, -v79, v55, v84
    v_fma_f32 v79, v79, v53, v85
    ds_read_b128 v[80:83], v97 offset:5120
    ds_write_b128 v97, v[72:75] offset:13312
    ds_write_b128 v97, v[76:79] offset:21504
    s_waitcnt lgkmcnt(0)
    v_fma_f32 v70, v52, v72, v80
    v_fma_f32 v71, v52, v74, v82
    v_fma_f32 v69, -v54, v74, v70
    v_fma_f32 v74, v54, v72, v71
    v_mov_b32 v72, v69
    v_mul_f32 v84, v76, v52
    v_mul_f32 v85, v76, v54
    v_fma_f32 v76, -v78, v54, v84
    v_fma_f32 v78, v78, v52, v85
    v_fma_f32 v70, v53, v73, v81
    v_fma_f32 v71, v53, v75, v83
    v_fma_f32 v69, -v55, v75, v70
    v_fma_f32 v75, v55, v73, v71
    v_mov_b32 v73, v69
    v_mul_f32 v84, v77, v53
    v_mul_f32 v85, v77, v55
    v_fma_f32 v77, -v79, v55, v84
    v_fma_f32 v79, v79, v53, v85
    ds_read_b128 v[80:83], v97 offset:5632
    ds_write_b128 v97, v[72:75] offset:13824
    ds_write_b128 v97, v[76:79] offset:22016
    s_waitcnt lgkmcnt(0)
    v_fma_f32 v70, v52, v72, v80
    v_fma_f32 v71, v52, v74, v82
    v_fma_f32 v69, -v54, v74, v70
    v_fma_f32 v74, v54, v72, v71
    v_mov_b32 v72, v69
    v_mul_f32 v84, v76, v52
    v_mul_f32 v85, v76, v54
    v_fma_f32 v76, -v78, v54, v84
    v_fma_f32 v78, v78, v52, v85
    v_fma_f32 v70, v53, v73, v81
    v_fma_f32 v71, v53, v75, v83
    v_fma_f32 v69, -v55, v75, v70
    v_fma_f32 v75, v55, v73, v71
    v_mov_b32 v73, v69
    v_mul_f32 v84, v77, v53
    v_mul_f32 v85, v77, v55
    v_fma_f32 v77, -v79, v55, v84
    v_fma_f32 v79, v79, v53, v85
    ds_read_b128 v[80:83], v97 offset:6144
    ds_write_b128 v97, v[72:75] offset:14336
    ds_write_b128 v97, v[76:79] offset:22528
    s_waitcnt lgkmcnt(0)
    v_fma_f32 v70, v52, v72, v80
    v_fma_f32 v71, v52, v74, v82
    v_fma_f32 v69, -v54, v74, v70
    v_fma_f32 v74, v54, v72, v71
    v_mov_b32 v72, v69
    v_mul_f32 v84, v76, v52
    v_mul_f32 v85, v76, v54
    v_fma_f32 v76, -v78, v54, v84
    v_fma_f32 v78, v78, v52, v85
    v_fma_f32 v70, v53, v73, v81
    v_fma_f32 v71, v53, v75, v83
    v_fma_f32 v69, -v55, v75, v70
    v_fma_f32 v75, v55, v73, v71
    v_mov_b32 v73, v69
    v_mul_f32 v84, v77, v53
    v_mul_f32 v85, v77, v55
    v_fma_f32 v77, -v79, v55, v84
    v_fma_f32 v79, v79, v53, v85
    ds_read_b128 v[80:83], v97 offset:6656
    ds_write_b128 v97, v[72:75] offset:14848
    ds_write_b128 v97, v[76:79] offset:23040
    s_waitcnt lgkmcnt(0)
    v_fma_f32 v70, v52, v72, v80
    v_fma_f32 v71, v52, v74, v82
    v_fma_f32 v69, -v54, v74, v70
    v_fma_f32 v74, v54, v72, v71
    v_mov_b32 v72, v69
    v_mul_f32 v84, v76, v52
    v_mul_f32 v85, v76, v54
    v_fma_f32 v76, -v78, v54, v84
    v_fma_f32 v78, v78, v52, v85
    v_fma_f32 v70, v53, v73, v81
    v_fma_f32 v71, v53, v75, v83
    v_fma_f32 v69, -v55, v75, v70
    v_fma_f32 v75, v55, v73, v71
    v_mov_b32 v73, v69
    v_mul_f32 v84, v77, v53
    v_mul_f32 v85, v77, v55
    v_fma_f32 v77, -v79, v55, v84
    v_fma_f32 v79, v79, v53, v85
    ds_read_b128 v[80:83], v97 offset:7168
    ds_write_b128 v97, v[72:75] offset:15360
    ds_write_b128 v97, v[76:79] offset:23552
    s_waitcnt lgkmcnt(0)
    v_fma_f32 v70, v52, v72, v80
    v_fma_f32 v71, v52, v74, v82
    v_fma_f32 v69, -v54, v74, v70
    v_fma_f32 v74, v54, v72, v71
    v_mov_b32 v72, v69
    v_mul_f32 v84, v76, v52
    v_mul_f32 v85, v76, v54
    v_fma_f32 v76, -v78, v54, v84
    v_fma_f32 v78, v78, v52, v85
    v_fma_f32 v70, v53, v73, v81
    v_fma_f32 v71, v53, v75, v83
    v_fma_f32 v69, -v55, v75, v70
    v_fma_f32 v75, v55, v73, v71
    v_mov_b32 v73, v69
    v_mul_f32 v84, v77, v53
    v_mul_f32 v85, v77, v55
    v_fma_f32 v77, -v79, v55, v84
    v_fma_f32 v79, v79, v53, v85
    ds_read_b128 v[80:83], v97 offset:7680
    ds_write_b128 v97, v[72:75] offset:15872
    ds_write_b128 v97, v[76:79] offset:24064
    s_waitcnt lgkmcnt(0)
    v_fma_f32 v70, v52, v72, v80
    v_fma_f32 v71, v52, v74, v82
    v_fma_f32 v69, -v54, v74, v70
    v_fma_f32 v74, v54, v72, v71
    v_mov_b32 v72, v69
    v_mul_f32 v84, v76, v52
    v_mul_f32 v85, v76, v54
    v_fma_f32 v76, -v78, v54, v84
    v_fma_f32 v78, v78, v52, v85
    v_fma_f32 v70, v53, v73, v81
    v_fma_f32 v71, v53, v75, v83
    v_fma_f32 v69, -v55, v75, v70
    v_fma_f32 v75, v55, v73, v71
    v_mov_b32 v73, v69
    v_mul_f32 v84, v77, v53
    v_mul_f32 v85, v77, v55
    v_fma_f32 v77, -v79, v55, v84
    v_fma_f32 v79, v79, v53, v85
    s_lshl_b32 s7, s3, 3
    s_add_u32 s7, s7, s4
    s_lshl_b32 s7, s7, 9
    s_add_u32 s7, s7, 12582912
    v_add_u32 v18, s7, v17
    buffer_store_dwordx4 v[72:75], v18, s[20:23], 0 offen sc1
    s_waitcnt vmcnt(0)
    s_mov_b32 s48, s42
    s_mov_b32 s49, s43
    s_mov_b32 s50, 256
    s_mov_b32 s51, 0x00020000
    s_lshl_b32 s7, 1, s3
    v_mov_b32 v19, s7
    s_lshl_b32 s52, s4, 2
    v_mov_b32 v86, s52
    v_cmp_eq_u32 vcc, 0, v2
    s_and_saveexec_b64 s[60:61], vcc
    buffer_atomic_or v19, v86, s[48:51], 0 offen sc1
    s_mov_b64 exec, s[60:61]
    s_sub_u32 s53, s7, 1
K1_POLL:
    buffer_load_dword v87, v86, s[48:51], 0 offen sc1
    s_waitcnt vmcnt(0)
    v_readfirstlane_b32 s54, v87
    s_and_b32 s54, s54, s53
    s_cmp_eq_u32 s54, s53
    s_cbranch_scc1 K1_GOT
    s_sleep 2
    s_branch K1_POLL
K1_GOT:
    ds_write_b128 v97, v[76:79] offset:24576
    s_waitcnt lgkmcnt(0)
K1_WAITC:
    s_barrier
    v_lshlrev_b32 v17, 4, v12
    v_add_u32 v97, 67584, v17
    s_add_u32 s54, s5, 0
    s_cmp_ge_u32 s54, s3
    s_cbranch_scc1 K1_SK0
    s_lshl_b32 s7, s54, 3
    s_add_u32 s7, s7, s4
    s_lshl_b32 s7, s7, 9
    s_add_u32 s7, s7, 12582912
    v_add_u32 v18, s7, v17
    buffer_load_dwordx4 v[80:83], v18, s[20:23], 0 offen sc1
    s_lshl_b32 s7, s54, 9
    v_add_u32 v19, s7, v97
    s_waitcnt vmcnt(0)
    ds_write_b128 v19, v[80:83] offset:28672
    s_waitcnt lgkmcnt(0)
K1_SK0:
    s_add_u32 s54, s5, 8
    s_cmp_ge_u32 s54, s3
    s_cbranch_scc1 K1_SK1
    s_lshl_b32 s7, s54, 3
    s_add_u32 s7, s7, s4
    s_lshl_b32 s7, s7, 9
    s_add_u32 s7, s7, 12582912
    v_add_u32 v18, s7, v17
    buffer_load_dwordx4 v[80:83], v18, s[20:23], 0 offen sc1
    s_lshl_b32 s7, s54, 9
    v_add_u32 v19, s7, v97
    s_waitcnt vmcnt(0)
    ds_write_b128 v19, v[80:83] offset:28672
    s_waitcnt lgkmcnt(0)
K1_SK1:
    s_barrier
    ds_read_b128 v[76:79], v97 offset:24576
    v_mov_b32 v80, 0
    v_mov_b32 v81, 0
    v_mov_b32 v82, 0
    v_mov_b32 v83, 0
    s_mov_b32 s55, 0
    v_mov_b32 v19, v97
    s_waitcnt lgkmcnt(0)
K1_HORN:
    s_cmp_ge_u32 s55, s3
    s_cbranch_scc1 K1_HDONE
    ds_read_b128 v[84:87], v19 offset:28672
    v_add_u32 v19, 512, v19
    s_waitcnt lgkmcnt(0)
    v_fma_f32 v70, v76, v80, v84
    v_fma_f32 v71, v76, v82, v86
    v_fma_f32 v69, -v78, v82, v70
    v_fma_f32 v82, v78, v80, v71
    v_mov_b32 v80, v69
    v_fma_f32 v70, v77, v81, v85
    v_fma_f32 v71, v77, v83, v87
    v_fma_f32 v69, -v79, v83, v70
    v_fma_f32 v83, v79, v81, v71
    v_mov_b32 v81, v69
    s_add_u32 s55, s55, 1
    s_branch K1_HORN
K1_HDONE:
    ds_read_b128 v[72:75], v16 offset:8192
    ds_read_b128 v[76:79], v16 offset:16384
    s_waitcnt lgkmcnt(0)
    v_fma_f32 v70, v76, v80, v72
    v_fma_f32 v71, v76, v82, v74
    v_fma_f32 v69, -v78, v82, v70
    v_fma_f32 v74, v78, v80, v71
    v_mov_b32 v72, v69
    v_fma_f32 v70, v77, v81, v73
    v_fma_f32 v71, v77, v83, v75
    v_fma_f32 v69, -v79, v83, v70
    v_fma_f32 v75, v79, v81, v71
    v_mov_b32 v73, v69
    s_lshl_b32 s7, s3, 7
    v_lshl_add_u32 v18, v13, 3, s7
    v_lshlrev_b32 v18, 11, v18
    s_lshl_b32 s7, s4, 7
    s_add_u32 s7, s7, 8388608
    v_lshl_add_u32 v19, v12, 2, s7
    v_add_u32 v18, v18, v19
    v_add_u32 v19, 4096, v18
    v_mul_f32 v84, v44, v72
    v_mul_f32 v85, v44, v74
    v_fma_f32 v84, -v46, v74, v84
    v_fma_f32 v74, v46, v72, v85
    v_mov_b32 v72, v84
    v_add_f32 v86, v100, v72
    v_add_f32 v87, v102, v74
    v_mul_f32 v88, v48, v86
    v_fma_f32 v90, -v50, v87, v88
    v_mul_f32 v88, v48, v87
    v_fma_f32 v88, v50, v86, v88
    v_sub_f32 v92, 0, v88
    v_mul_f32 v84, v45, v73
    v_mul_f32 v85, v45, v75
    v_fma_f32 v84, -v47, v75, v84
    v_fma_f32 v75, v47, v73, v85
    v_mov_b32 v73, v84
    v_add_f32 v86, v101, v73
    v_add_f32 v87, v103, v75
    v_mul_f32 v88, v49, v86
    v_fma_f32 v91, -v51, v87, v88
    v_mul_f32 v88, v49, v87
    v_fma_f32 v88, v51, v86, v88
    v_sub_f32 v93, 0, v88
    v_cvt_pk_bf16_f32 v94, v90, v91
    v_cvt_pk_bf16_f32 v95, v92, v93
    v_add_u32 v89, 0, v18
    buffer_store_dword v94, v89, s[20:23], 0 offen
    buffer_store_dword v95, v89, s[20:23], 0 offen offset:1024
    v_mul_f32 v84, v44, v72
    v_mul_f32 v85, v44, v74
    v_fma_f32 v84, -v46, v74, v84
    v_fma_f32 v74, v46, v72, v85
    v_mov_b32 v72, v84
    v_add_f32 v86, v104, v72
    v_add_f32 v87, v106, v74
    v_mul_f32 v88, v48, v86
    v_fma_f32 v90, -v50, v87, v88
    v_mul_f32 v88, v48, v87
    v_fma_f32 v88, v50, v86, v88
    v_sub_f32 v92, 0, v88
    v_mul_f32 v84, v45, v73
    v_mul_f32 v85, v45, v75
    v_fma_f32 v84, -v47, v75, v84
    v_fma_f32 v75, v47, v73, v85
    v_mov_b32 v73, v84
    v_add_f32 v86, v105, v73
    v_add_f32 v87, v107, v75
    v_mul_f32 v88, v49, v86
    v_fma_f32 v91, -v51, v87, v88
    v_mul_f32 v88, v49, v87
    v_fma_f32 v88, v51, v86, v88
    v_sub_f32 v93, 0, v88
    v_cvt_pk_bf16_f32 v94, v90, v91
    v_cvt_pk_bf16_f32 v95, v92, v93
    v_add_u32 v89, 2048, v18
    buffer_store_dword v94, v89, s[20:23], 0 offen
    buffer_store_dword v95, v89, s[20:23], 0 offen offset:1024
    v_mul_f32 v84, v44, v72
    v_mul_f32 v85, v44, v74
    v_fma_f32 v84, -v46, v74, v84
    v_fma_f32 v74, v46, v72, v85
    v_mov_b32 v72, v84
    v_add_f32 v86, v108, v72
    v_add_f32 v87, v110, v74
    v_mul_f32 v88, v48, v86
    v_fma_f32 v90, -v50, v87, v88
    v_mul_f32 v88, v48, v87
    v_fma_f32 v88, v50, v86, v88
    v_sub_f32 v92, 0, v88
    v_mul_f32 v84, v45, v73
    v_mul_f32 v85, v45, v75
    v_fma_f32 v84, -v47, v75, v84
    v_fma_f32 v75, v47, v73, v85
    v_mov_b32 v73, v84
    v_add_f32 v86, v109, v73
    v_add_f32 v87, v111, v75
    v_mul_f32 v88, v49, v86
    v_fma_f32 v91, -v51, v87, v88
    v_mul_f32 v88, v49, v87
    v_fma_f32 v88, v51, v86, v88
    v_sub_f32 v93, 0, v88
    v_cvt_pk_bf16_f32 v94, v90, v91
    v_cvt_pk_bf16_f32 v95, v92, v93
    v_add_u32 v89, 4096, v18
    buffer_store_dword v94, v89, s[20:23], 0 offen
    buffer_store_dword v95, v89, s[20:23], 0 offen offset:1024
    v_mul_f32 v84, v44, v72
    v_mul_f32 v85, v44, v74
    v_fma_f32 v84, -v46, v74, v84
    v_fma_f32 v74, v46, v72, v85
    v_mov_b32 v72, v84
    v_add_f32 v86, v112, v72
    v_add_f32 v87, v114, v74
    v_mul_f32 v88, v48, v86
    v_fma_f32 v90, -v50, v87, v88
    v_mul_f32 v88, v48, v87
    v_fma_f32 v88, v50, v86, v88
    v_sub_f32 v92, 0, v88
    v_mul_f32 v84, v45, v73
    v_mul_f32 v85, v45, v75
    v_fma_f32 v84, -v47, v75, v84
    v_fma_f32 v75, v47, v73, v85
    v_mov_b32 v73, v84
    v_add_f32 v86, v113, v73
    v_add_f32 v87, v115, v75
    v_mul_f32 v88, v49, v86
    v_fma_f32 v91, -v51, v87, v88
    v_mul_f32 v88, v49, v87
    v_fma_f32 v88, v51, v86, v88
    v_sub_f32 v93, 0, v88
    v_cvt_pk_bf16_f32 v94, v90, v91
    v_cvt_pk_bf16_f32 v95, v92, v93
    v_add_u32 v89, 6144, v18
    buffer_store_dword v94, v89, s[20:23], 0 offen
    buffer_store_dword v95, v89, s[20:23], 0 offen offset:1024
    v_mul_f32 v84, v44, v72
    v_mul_f32 v85, v44, v74
    v_fma_f32 v84, -v46, v74, v84
    v_fma_f32 v74, v46, v72, v85
    v_mov_b32 v72, v84
    v_add_f32 v86, v116, v72
    v_add_f32 v87, v118, v74
    v_mul_f32 v88, v48, v86
    v_fma_f32 v90, -v50, v87, v88
    v_mul_f32 v88, v48, v87
    v_fma_f32 v88, v50, v86, v88
    v_sub_f32 v92, 0, v88
    v_mul_f32 v84, v45, v73
    v_mul_f32 v85, v45, v75
    v_fma_f32 v84, -v47, v75, v84
    v_fma_f32 v75, v47, v73, v85
    v_mov_b32 v73, v84
    v_add_f32 v86, v117, v73
    v_add_f32 v87, v119, v75
    v_mul_f32 v88, v49, v86
    v_fma_f32 v91, -v51, v87, v88
    v_mul_f32 v88, v49, v87
    v_fma_f32 v88, v51, v86, v88
    v_sub_f32 v93, 0, v88
    v_cvt_pk_bf16_f32 v94, v90, v91
    v_cvt_pk_bf16_f32 v95, v92, v93
    v_add_u32 v89, 8192, v18
    buffer_store_dword v94, v89, s[20:23], 0 offen
    buffer_store_dword v95, v89, s[20:23], 0 offen offset:1024
    v_mul_f32 v84, v44, v72
    v_mul_f32 v85, v44, v74
    v_fma_f32 v84, -v46, v74, v84
    v_fma_f32 v74, v46, v72, v85
    v_mov_b32 v72, v84
    v_add_f32 v86, v120, v72
    v_add_f32 v87, v122, v74
    v_mul_f32 v88, v48, v86
    v_fma_f32 v90, -v50, v87, v88
    v_mul_f32 v88, v48, v87
    v_fma_f32 v88, v50, v86, v88
    v_sub_f32 v92, 0, v88
    v_mul_f32 v84, v45, v73
    v_mul_f32 v85, v45, v75
    v_fma_f32 v84, -v47, v75, v84
    v_fma_f32 v75, v47, v73, v85
    v_mov_b32 v73, v84
    v_add_f32 v86, v121, v73
    v_add_f32 v87, v123, v75
    v_mul_f32 v88, v49, v86
    v_fma_f32 v91, -v51, v87, v88
    v_mul_f32 v88, v49, v87
    v_fma_f32 v88, v51, v86, v88
    v_sub_f32 v93, 0, v88
    v_cvt_pk_bf16_f32 v94, v90, v91
    v_cvt_pk_bf16_f32 v95, v92, v93
    v_add_u32 v89, 10240, v18
    buffer_store_dword v94, v89, s[20:23], 0 offen
    buffer_store_dword v95, v89, s[20:23], 0 offen offset:1024
    v_mul_f32 v84, v44, v72
    v_mul_f32 v85, v44, v74
    v_fma_f32 v84, -v46, v74, v84
    v_fma_f32 v74, v46, v72, v85
    v_mov_b32 v72, v84
    v_add_f32 v86, v124, v72
    v_add_f32 v87, v126, v74
    v_mul_f32 v88, v48, v86
    v_fma_f32 v90, -v50, v87, v88
    v_mul_f32 v88, v48, v87
    v_fma_f32 v88, v50, v86, v88
    v_sub_f32 v92, 0, v88
    v_mul_f32 v84, v45, v73
    v_mul_f32 v85, v45, v75
    v_fma_f32 v84, -v47, v75, v84
    v_fma_f32 v75, v47, v73, v85
    v_mov_b32 v73, v84
    v_add_f32 v86, v125, v73
    v_add_f32 v87, v127, v75
    v_mul_f32 v88, v49, v86
    v_fma_f32 v91, -v51, v87, v88
    v_mul_f32 v88, v49, v87
    v_fma_f32 v88, v51, v86, v88
    v_sub_f32 v93, 0, v88
    v_cvt_pk_bf16_f32 v94, v90, v91
    v_cvt_pk_bf16_f32 v95, v92, v93
    v_add_u32 v89, 12288, v18
    buffer_store_dword v94, v89, s[20:23], 0 offen
    buffer_store_dword v95, v89, s[20:23], 0 offen offset:1024
    v_mul_f32 v84, v44, v72
    v_mul_f32 v85, v44, v74
    v_fma_f32 v84, -v46, v74, v84
    v_fma_f32 v74, v46, v72, v85
    v_mov_b32 v72, v84
    v_add_f32 v86, v128, v72
    v_add_f32 v87, v130, v74
    v_mul_f32 v88, v48, v86
    v_fma_f32 v90, -v50, v87, v88
    v_mul_f32 v88, v48, v87
    v_fma_f32 v88, v50, v86, v88
    v_sub_f32 v92, 0, v88
    v_mul_f32 v84, v45, v73
    v_mul_f32 v85, v45, v75
    v_fma_f32 v84, -v47, v75, v84
    v_fma_f32 v75, v47, v73, v85
    v_mov_b32 v73, v84
    v_add_f32 v86, v129, v73
    v_add_f32 v87, v131, v75
    v_mul_f32 v88, v49, v86
    v_fma_f32 v91, -v51, v87, v88
    v_mul_f32 v88, v49, v87
    v_fma_f32 v88, v51, v86, v88
    v_sub_f32 v93, 0, v88
    v_cvt_pk_bf16_f32 v94, v90, v91
    v_cvt_pk_bf16_f32 v95, v92, v93
    v_add_u32 v89, 14336, v18
    buffer_store_dword v94, v89, s[20:23], 0 offen
    buffer_store_dword v95, v89, s[20:23], 0 offen offset:1024
K1_END:
    s_endpgm
.section .rodata,"a"
.p2align 6
.amdhsa_kernel k1_kernel
  .amdhsa_next_free_vgpr 256
  .amdhsa_next_free_sgpr 102
  .amdhsa_accum_offset 136
  .amdhsa_group_segment_fixed_size 0
  .amdhsa_kernarg_size 144
  .amdhsa_user_sgpr_count 2
  .amdhsa_user_sgpr_kernarg_segment_ptr 1
  .amdhsa_system_sgpr_workgroup_id_x 1
.end_amdhsa_kernel
.text
.globl k2_kernel
.p2align 8
.type k2_kernel,@function
k2_kernel:
    s_cmp_ge_u32 s2, 256
    s_cbranch_scc1 K2_END
    s_load_dwordx2 s[24:25], s[0:1], 0
    s_load_dwordx4 s[28:31], s[0:1], 40
    s_load_dwordx2 s[32:33], s[0:1], 64
    s_load_dwordx4 s[36:39], s[0:1], 96
    s_load_dwordx2 s[40:41], s[0:1], 120
    s_load_dwordx2 s[44:45], s[0:1], 136
    s_and_b32 s3, s2, 7
    s_lshl_b32 s3, s3, 2
    s_bfe_u32 s6, s2, 0x20003
    s_add_u32 s3, s3, s6
    s_lshr_b32 s4, s2, 5
    v_lshrrev_b32 v1, 6, v0
    s_nop 0
    v_readfirstlane_b32 s5, v1
    v_and_b32 v2, 63, v0
    v_and_b32 v3, 31, v0
    v_bfe_u32 v4, v0, 5, 1
    s_waitcnt lgkmcnt(0)
    s_mov_b32 s20, s44
    s_mov_b32 s21, s45
    s_mov_b32 s22, 16777216
    s_mov_b32 s23, 0x00020000
    s_mov_b32 s12, s36
    s_mov_b32 s13, s37
    s_mov_b32 s14, 1835008
    s_mov_b32 s15, 0x00020000
    s_cmp_lt_u32 s5, 4
    s_cselect_b32 s16, s28, s30
    s_cselect_b32 s17, s29, s31
    s_mov_b32 s18, 524288
    s_mov_b32 s19, 0x00020000
    v_accvgpr_write_b32 a0, 0
    v_accvgpr_write_b32 a1, 0
    v_accvgpr_write_b32 a2, 0
    v_accvgpr_write_b32 a3, 0
    v_accvgpr_write_b32 a4, 0
    v_accvgpr_write_b32 a5, 0
    v_accvgpr_write_b32 a6, 0
    v_accvgpr_write_b32 a7, 0
    v_accvgpr_write_b32 a8, 0
    v_accvgpr_write_b32 a9, 0
    v_accvgpr_write_b32 a10, 0
    v_accvgpr_write_b32 a11, 0
    v_accvgpr_write_b32 a12, 0
    v_accvgpr_write_b32 a13, 0
    v_accvgpr_write_b32 a14, 0
    v_accvgpr_write_b32 a15, 0
    v_accvgpr_write_b32 a16, 0
    v_accvgpr_write_b32 a17, 0
    v_accvgpr_write_b32 a18, 0
    v_accvgpr_write_b32 a19, 0
    v_accvgpr_write_b32 a20, 0
    v_accvgpr_write_b32 a21, 0
    v_accvgpr_write_b32 a22, 0
    v_accvgpr_write_b32 a23, 0
    v_accvgpr_write_b32 a24, 0
    v_accvgpr_write_b32 a25, 0
    v_accvgpr_write_b32 a26, 0
    v_accvgpr_write_b32 a27, 0
    v_accvgpr_write_b32 a28, 0
    v_accvgpr_write_b32 a29, 0
    v_accvgpr_write_b32 a30, 0
    v_accvgpr_write_b32 a31, 0
    v_accvgpr_write_b32 a32, 0
    v_accvgpr_write_b32 a33, 0
    v_accvgpr_write_b32 a34, 0
    v_accvgpr_write_b32 a35, 0
    v_accvgpr_write_b32 a36, 0
    v_accvgpr_write_b32 a37, 0
    v_accvgpr_write_b32 a38, 0
    v_accvgpr_write_b32 a39, 0
    v_accvgpr_write_b32 a40, 0
    v_accvgpr_write_b32 a41, 0
    v_accvgpr_write_b32 a42, 0
    v_accvgpr_write_b32 a43, 0
    v_accvgpr_write_b32 a44, 0
    v_accvgpr_write_b32 a45, 0
    v_accvgpr_write_b32 a46, 0
    v_accvgpr_write_b32 a47, 0
    v_accvgpr_write_b32 a48, 0
    v_accvgpr_write_b32 a49, 0
    v_accvgpr_write_b32 a50, 0
    v_accvgpr_write_b32 a51, 0
    v_accvgpr_write_b32 a52, 0
    v_accvgpr_write_b32 a53, 0
    v_accvgpr_write_b32 a54, 0
    v_accvgpr_write_b32 a55, 0
    v_accvgpr_write_b32 a56, 0
    v_accvgpr_write_b32 a57, 0
    v_accvgpr_write_b32 a58, 0
    v_accvgpr_write_b32 a59, 0
    v_accvgpr_write_b32 a60, 0
    v_accvgpr_write_b32 a61, 0
    v_accvgpr_write_b32 a62, 0
    v_accvgpr_write_b32 a63, 0
    v_accvgpr_write_b32 a64, 0
    v_accvgpr_write_b32 a65, 0
    v_accvgpr_write_b32 a66, 0
    v_accvgpr_write_b32 a67, 0
    v_accvgpr_write_b32 a68, 0
    v_accvgpr_write_b32 a69, 0
    v_accvgpr_write_b32 a70, 0
    v_accvgpr_write_b32 a71, 0
    v_accvgpr_write_b32 a72, 0
    v_accvgpr_write_b32 a73, 0
    v_accvgpr_write_b32 a74, 0
    v_accvgpr_write_b32 a75, 0
    v_accvgpr_write_b32 a76, 0
    v_accvgpr_write_b32 a77, 0
    v_accvgpr_write_b32 a78, 0
    v_accvgpr_write_b32 a79, 0
    v_accvgpr_write_b32 a80, 0
    v_accvgpr_write_b32 a81, 0
    v_accvgpr_write_b32 a82, 0
    v_accvgpr_write_b32 a83, 0
    v_accvgpr_write_b32 a84, 0
    v_accvgpr_write_b32 a85, 0
    v_accvgpr_write_b32 a86, 0
    v_accvgpr_write_b32 a87, 0
    v_accvgpr_write_b32 a88, 0
    v_accvgpr_write_b32 a89, 0
    v_accvgpr_write_b32 a90, 0
    v_accvgpr_write_b32 a91, 0
    v_accvgpr_write_b32 a92, 0
    v_accvgpr_write_b32 a93, 0
    v_accvgpr_write_b32 a94, 0
    v_accvgpr_write_b32 a95, 0
    v_accvgpr_write_b32 a96, 0
    v_accvgpr_write_b32 a97, 0
    v_accvgpr_write_b32 a98, 0
    v_accvgpr_write_b32 a99, 0
    v_accvgpr_write_b32 a100, 0
    v_accvgpr_write_b32 a101, 0
    v_accvgpr_write_b32 a102, 0
    v_accvgpr_write_b32 a103, 0
    v_accvgpr_write_b32 a104, 0
    v_accvgpr_write_b32 a105, 0
    v_accvgpr_write_b32 a106, 0
    v_accvgpr_write_b32 a107, 0
    v_accvgpr_write_b32 a108, 0
    v_accvgpr_write_b32 a109, 0
    v_accvgpr_write_b32 a110, 0
    v_accvgpr_write_b32 a111, 0
    v_accvgpr_write_b32 a112, 0
    v_accvgpr_write_b32 a113, 0
    v_accvgpr_write_b32 a114, 0
    v_accvgpr_write_b32 a115, 0
    v_accvgpr_write_b32 a116, 0
    v_accvgpr_write_b32 a117, 0
    v_accvgpr_write_b32 a118, 0
    v_accvgpr_write_b32 a119, 0
    v_accvgpr_write_b32 a120, 0
    v_accvgpr_write_b32 a121, 0
    v_accvgpr_write_b32 a122, 0
    v_accvgpr_write_b32 a123, 0
    v_accvgpr_write_b32 a124, 0
    v_accvgpr_write_b32 a125, 0
    v_accvgpr_write_b32 a126, 0
    v_accvgpr_write_b32 a127, 0
    v_lshrrev_b32 v5, 4, v2
    v_and_b32 v6, 15, v2
    s_lshl_b32 s6, s5, 3
    s_add_u32 s6, s6, 0
    v_add_u32 v7, s6, v5
    v_and_b32 v12, 7, v7
    v_xor_b32 v12, v12, v6
    s_lshl_b32 s6, s3, 6
    v_add_u32 v13, s6, v7
    v_lshlrev_b32 v20, 11, v13
    v_lshl_add_u32 v20, v12, 4, v20
    v_add_u32 v20, 8388608, v20
    v_mul_u32_u24 v22, 3584, v13
    v_lshl_add_u32 v22, v12, 4, v22
    s_lshl_b32 s6, s4, 6
    v_add_u32 v13, s6, v7
    v_lshlrev_b32 v24, 10, v13
    v_lshl_add_u32 v24, v12, 4, v24
    s_lshl_b32 s6, s5, 4
    s_add_u32 s6, s6, 0
    v_lshrrev_b32 v7, 3, v2
    v_add_u32 v7, s6, v7
    v_bfe_u32 v12, v7, 1, 1
    v_lshlrev_b32 v12, 2, v12
    v_and_b32 v13, 7, v2
    v_xor_b32 v12, v12, v13
    v_lshlrev_b32 v26, 10, v7
    v_lshl_add_u32 v26, v12, 4, v26
    s_lshl_b32 s6, s4, 7
    v_add_u32 v26, s6, v26
    s_lshl_b32 s6, s5, 3
    s_add_u32 s6, s6, 4
    v_add_u32 v7, s6, v5
    v_and_b32 v12, 7, v7
    v_xor_b32 v12, v12, v6
    s_lshl_b32 s6, s3, 6
    v_add_u32 v13, s6, v7
    v_lshlrev_b32 v21, 11, v13
    v_lshl_add_u32 v21, v12, 4, v21
    v_add_u32 v21, 8388608, v21
    v_mul_u32_u24 v23, 3584, v13
    v_lshl_add_u32 v23, v12, 4, v23
    s_lshl_b32 s6, s4, 6
    v_add_u32 v13, s6, v7
    v_lshlrev_b32 v25, 10, v13
    v_lshl_add_u32 v25, v12, 4, v25
    s_lshl_b32 s6, s5, 4
    s_add_u32 s6, s6, 8
    v_lshrrev_b32 v7, 3, v2
    v_add_u32 v7, s6, v7
    v_bfe_u32 v12, v7, 1, 1
    v_lshlrev_b32 v12, 2, v12
    v_and_b32 v13, 7, v2
    v_xor_b32 v12, v12, v13
    v_lshlrev_b32 v27, 10, v7
    v_lshl_add_u32 v27, v12, 4, v27
    s_lshl_b32 s6, s4, 7
    v_add_u32 v27, s6, v27
    s_mov_b32 s48, s28
    s_mov_b32 s49, s29
    s_mov_b32 s50, 524288
    s_mov_b32 s51, 0x00020000
    s_mov_b32 s52, s30
    s_mov_b32 s53, s31
    s_mov_b32 s54, 524288
    s_mov_b32 s55, 0x00020000
    s_lshl_b32 s58, s5, 11
    v_add_u32 v7, 0, v3
    v_and_b32 v12, 7, v7
    s_lshl_b32 s6, s5, 1
    v_add_u32 v13, s6, v4
    v_xor_b32 v12, v12, v13
    v_lshlrev_b32 v80, 8, v7
    v_lshl_add_u32 v80, v12, 4, v80
    v_add_u32 v7, 32, v3
    v_and_b32 v12, 7, v7
    s_lshl_b32 s6, s5, 1
    v_add_u32 v13, s6, v4
    v_xor_b32 v12, v12, v13
    v_lshlrev_b32 v81, 8, v7
    v_lshl_add_u32 v81, v12, 4, v81
    v_bfe_u32 v7, v2, 5, 1
    v_bfe_u32 v12, v2, 2, 2
    v_lshl_add_u32 v7, v7, 3, v12
    s_lshl_b32 s6, s5, 4
    s_add_u32 s6, s6, 0
    v_add_u32 v7, s6, v7
    v_bfe_u32 v12, v2, 4, 1
    v_lshlrev_b32 v12, 1, v12
    v_bfe_u32 v13, v2, 1, 1
    v_add_u32 v12, v12, v13
    v_add_u32 v12, 0, v12
    v_bfe_u32 v13, v7, 1, 1
    v_lshlrev_b32 v13, 2, v13
    v_xor_b32 v12, v12, v13
    v_lshlrev_b32 v82, 7, v7
    v_lshl_add_u32 v82, v12, 4, v82
    v_and_b32 v13, 1, v2
    v_lshl_add_u32 v82, v13, 3, v82
    v_add_u32 v82, 16384, v82
    v_bfe_u32 v7, v2, 5, 1
    v_bfe_u32 v12, v2, 2, 2
    v_lshl_add_u32 v7, v7, 3, v12
    s_lshl_b32 s6, s5, 4
    s_add_u32 s6, s6, 0
    v_add_u32 v7, s6, v7
    v_bfe_u32 v12, v2, 4, 1
    v_lshlrev_b32 v12, 1, v12
    v_bfe_u32 v13, v2, 1, 1
    v_add_u32 v12, v12, v13
    v_add_u32 v12, 4, v12
    v_bfe_u32 v13, v7, 1, 1
    v_lshlrev_b32 v13, 2, v13
    v_xor_b32 v12, v12, v13
    v_lshlrev_b32 v83, 7, v7
    v_lshl_add_u32 v83, v12, 4, v83
    v_and_b32 v13, 1, v2
    v_lshl_add_u32 v83, v13, 3, v83
    v_add_u32 v83, 16384, v83
    v_bfe_u32 v7, v2, 5, 1
    v_bfe_u32 v12, v2, 2, 2
    v_lshl_add_u32 v7, v7, 3, v12
    s_lshl_b32 s6, s5, 4
    s_add_u32 s6, s6, 4
    v_add_u32 v7, s6, v7
    v_bfe_u32 v12, v2, 4, 1
    v_lshlrev_b32 v12, 1, v12
    v_bfe_u32 v13, v2, 1, 1
    v_add_u32 v12, v12, v13
    v_add_u32 v12, 0, v12
    v_bfe_u32 v13, v7, 1, 1
    v_lshlrev_b32 v13, 2, v13
    v_xor_b32 v12, v12, v13
    v_lshlrev_b32 v84, 7, v7
    v_lshl_add_u32 v84, v12, 4, v84
    v_and_b32 v13, 1, v2
    v_lshl_add_u32 v84, v13, 3, v84
    v_add_u32 v84, 16384, v84
    v_bfe_u32 v7, v2, 5, 1
    v_bfe_u32 v12, v2, 2, 2
    v_lshl_add_u32 v7, v7, 3, v12
    s_lshl_b32 s6, s5, 4
    s_add_u32 s6, s6, 4
    v_add_u32 v7, s6, v7
    v_bfe_u32 v12, v2, 4, 1
    v_lshlrev_b32 v12, 1, v12
    v_bfe_u32 v13, v2, 1, 1
    v_add_u32 v12, v12, v13
    v_add_u32 v12, 4, v12
    v_bfe_u32 v13, v7, 1, 1
    v_lshlrev_b32 v13, 2, v13
    v_xor_b32 v12, v12, v13
    v_lshlrev_b32 v85, 7, v7
    v_lshl_add_u32 v85, v12, 4, v85
    v_and_b32 v13, 1, v2
    v_lshl_add_u32 v85, v13, 3, v85
    v_add_u32 v85, 16384, v85
    v_add_u32 v110, 65536, v80
    v_add_u32 v111, 65536, v81
    v_add_u32 v112, 65536, v82
    v_add_u32 v113, 65536, v83
    v_add_u32 v114, 65536, v84
    v_add_u32 v115, 65536, v85
    s_add_u32 s59, s58, 0
    s_mov_b32 m0, s59
    s_mov_b32 s60, 0
    buffer_load_dwordx4 v20, s[20:23], s60 offen lds
    s_add_u32 s59, s58, 1024
    s_mov_b32 m0, s59
    s_mov_b32 s60, 0
    buffer_load_dwordx4 v21, s[20:23], s60 offen lds
    s_add_u32 s59, s58, 16384
    s_mov_b32 m0, s59
    s_mov_b32 s60, 0
    buffer_load_dwordx4 v24, s[48:51], s60 offen lds
    s_add_u32 s59, s58, 17408
    s_mov_b32 m0, s59
    s_mov_b32 s60, 0
    buffer_load_dwordx4 v25, s[48:51], s60 offen lds
    s_add_u32 s59, s58, 32768
    s_mov_b32 m0, s59
    s_mov_b32 s60, 256
    buffer_load_dwordx4 v20, s[20:23], s60 offen lds
    s_add_u32 s59, s58, 33792
    s_mov_b32 m0, s59
    s_mov_b32 s60, 256
    buffer_load_dwordx4 v21, s[20:23], s60 offen lds
    s_add_u32 s59, s58, 49152
    s_mov_b32 m0, s59
    s_mov_b32 s60, 256
    buffer_load_dwordx4 v24, s[48:51], s60 offen lds
    s_add_u32 s59, s58, 50176
    s_mov_b32 m0, s59
    s_mov_b32 s60, 256
    buffer_load_dwordx4 v25, s[48:51], s60 offen lds
    s_add_u32 s59, s58, 65536
    s_mov_b32 m0, s59
    s_mov_b32 s60, 512
    buffer_load_dwordx4 v20, s[20:23], s60 offen lds
    s_add_u32 s59, s58, 66560
    s_mov_b32 m0, s59
    s_mov_b32 s60, 512
    buffer_load_dwordx4 v21, s[20:23], s60 offen lds
    s_add_u32 s59, s58, 81920
    s_mov_b32 m0, s59
    s_mov_b32 s60, 512
    buffer_load_dwordx4 v24, s[48:51], s60 offen lds
    s_add_u32 s59, s58, 82944
    s_mov_b32 m0, s59
    s_mov_b32 s60, 512
    buffer_load_dwordx4 v25, s[48:51], s60 offen lds
    s_waitcnt vmcnt(8)
    s_barrier
    ds_read_b128 v[88:91], v80 offset:0
    ds_read_b128 v[92:95], v81 offset:0
    ds_read_b128 v[100:103], v80 offset:16384
    ds_read_b128 v[104:107], v81 offset:16384
    s_add_u32 s59, s58, 98304
    s_mov_b32 m0, s59
    s_mov_b32 s60, 768
    buffer_load_dwordx4 v20, s[20:23], s60 offen lds
    s_add_u32 s59, s58, 99328
    s_mov_b32 m0, s59
    s_mov_b32 s60, 768
    buffer_load_dwordx4 v21, s[20:23], s60 offen lds
    s_add_u32 s59, s58, 114688
    s_mov_b32 m0, s59
    s_mov_b32 s60, 768
    buffer_load_dwordx4 v24, s[48:51], s60 offen lds
    s_add_u32 s59, s58, 115712
    s_mov_b32 m0, s59
    s_mov_b32 s60, 768
    buffer_load_dwordx4 v25, s[48:51], s60 offen lds
    s_waitcnt lgkmcnt(0)
    v_mfma_f32_32x32x16_bf16 a[0:15], v[88:91], v[100:103], a[0:15]
    v_mfma_f32_32x32x16_bf16 a[16:31], v[88:91], v[104:107], a[16:31]
    v_mfma_f32_32x32x16_bf16 a[32:47], v[92:95], v[100:103], a[32:47]
    v_mfma_f32_32x32x16_bf16 a[48:63], v[92:95], v[104:107], a[48:63]
    s_waitcnt vmcnt(8)
    s_barrier
    ds_read_b128 v[88:91], v80 offset:32768
    ds_read_b128 v[92:95], v81 offset:32768
    ds_read_b128 v[100:103], v80 offset:49152
    ds_read_b128 v[104:107], v81 offset:49152
    s_add_u32 s59, s58, 0
    s_mov_b32 m0, s59
    s_mov_b32 s60, 1024
    buffer_load_dwordx4 v20, s[20:23], s60 offen lds
    s_add_u32 s59, s58, 1024
    s_mov_b32 m0, s59
    s_mov_b32 s60, 1024
    buffer_load_dwordx4 v21, s[20:23], s60 offen lds
    s_add_u32 s59, s58, 16384
    s_mov_b32 m0, s59
    s_mov_b32 s60, 0
    buffer_load_dwordx4 v24, s[52:55], s60 offen lds
    s_add_u32 s59, s58, 17408
    s_mov_b32 m0, s59
    s_mov_b32 s60, 0
    buffer_load_dwordx4 v25, s[52:55], s60 offen lds
    s_waitcnt lgkmcnt(0)
    v_mfma_f32_32x32x16_bf16 a[0:15], v[88:91], v[100:103], a[0:15]
    v_mfma_f32_32x32x16_bf16 a[16:31], v[88:91], v[104:107], a[16:31]
    v_mfma_f32_32x32x16_bf16 a[32:47], v[92:95], v[100:103], a[32:47]
    v_mfma_f32_32x32x16_bf16 a[48:63], v[92:95], v[104:107], a[48:63]
    s_waitcnt vmcnt(8)
    s_barrier
    ds_read_b128 v[88:91], v110 offset:0
    ds_read_b128 v[92:95], v111 offset:0
    ds_read_b128 v[100:103], v110 offset:16384
    ds_read_b128 v[104:107], v111 offset:16384
    s_add_u32 s59, s58, 32768
    s_mov_b32 m0, s59
    s_mov_b32 s60, 1280
    buffer_load_dwordx4 v20, s[20:23], s60 offen lds
    s_add_u32 s59, s58, 33792
    s_mov_b32 m0, s59
    s_mov_b32 s60, 1280
    buffer_load_dwordx4 v21, s[20:23], s60 offen lds
    s_add_u32 s59, s58, 49152
    s_mov_b32 m0, s59
    s_mov_b32 s60, 256
    buffer_load_dwordx4 v24, s[52:55], s60 offen lds
    s_add_u32 s59, s58, 50176
    s_mov_b32 m0, s59
    s_mov_b32 s60, 256
    buffer_load_dwordx4 v25, s[52:55], s60 offen lds
    s_waitcnt lgkmcnt(0)
    v_mfma_f32_32x32x16_bf16 a[0:15], v[88:91], v[100:103], a[0:15]
    v_mfma_f32_32x32x16_bf16 a[16:31], v[88:91], v[104:107], a[16:31]
    v_mfma_f32_32x32x16_bf16 a[32:47], v[92:95], v[100:103], a[32:47]
    v_mfma_f32_32x32x16_bf16 a[48:63], v[92:95], v[104:107], a[48:63]
    s_waitcnt vmcnt(8)
    s_barrier
    ds_read_b128 v[88:91], v110 offset:32768
    ds_read_b128 v[92:95], v111 offset:32768
    ds_read_b128 v[100:103], v110 offset:49152
    ds_read_b128 v[104:107], v111 offset:49152
    s_add_u32 s59, s58, 65536
    s_mov_b32 m0, s59
    s_mov_b32 s60, 1536
    buffer_load_dwordx4 v20, s[20:23], s60 offen lds
    s_add_u32 s59, s58, 66560
    s_mov_b32 m0, s59
    s_mov_b32 s60, 1536
    buffer_load_dwordx4 v21, s[20:23], s60 offen lds
    s_add_u32 s59, s58, 81920
    s_mov_b32 m0, s59
    s_mov_b32 s60, 512
    buffer_load_dwordx4 v24, s[52:55], s60 offen lds
    s_add_u32 s59, s58, 82944
    s_mov_b32 m0, s59
    s_mov_b32 s60, 512
    buffer_load_dwordx4 v25, s[52:55], s60 offen lds
    s_waitcnt lgkmcnt(0)
    v_mfma_f32_32x32x16_bf16 a[0:15], v[88:91], v[100:103], a[0:15]
    v_mfma_f32_32x32x16_bf16 a[16:31], v[88:91], v[104:107], a[16:31]
    v_mfma_f32_32x32x16_bf16 a[32:47], v[92:95], v[100:103], a[32:47]
    v_mfma_f32_32x32x16_bf16 a[48:63], v[92:95], v[104:107], a[48:63]
    s_waitcnt vmcnt(8)
    s_barrier
    ds_read_b128 v[88:91], v80 offset:0
    ds_read_b128 v[92:95], v81 offset:0
    ds_read_b128 v[100:103], v80 offset:16384
    ds_read_b128 v[104:107], v81 offset:16384
    s_add_u32 s59, s58, 98304
    s_mov_b32 m0, s59
    s_mov_b32 s60, 1792
    buffer_load_dwordx4 v20, s[20:23], s60 offen lds
    s_add_u32 s59, s58, 99328
    s_mov_b32 m0, s59
    s_mov_b32 s60, 1792
    buffer_load_dwordx4 v21, s[20:23], s60 offen lds
    s_add_u32 s59, s58, 114688
    s_mov_b32 m0, s59
    s_mov_b32 s60, 768
    buffer_load_dwordx4 v24, s[52:55], s60 offen lds
    s_add_u32 s59, s58, 115712
    s_mov_b32 m0, s59
    s_mov_b32 s60, 768
    buffer_load_dwordx4 v25, s[52:55], s60 offen lds
    s_waitcnt lgkmcnt(0)
    v_mfma_f32_32x32x16_bf16 a[0:15], v[88:91], v[100:103], a[0:15]
    v_mfma_f32_32x32x16_bf16 a[16:31], v[88:91], v[104:107], a[16:31]
    v_mfma_f32_32x32x16_bf16 a[32:47], v[92:95], v[100:103], a[32:47]
    v_mfma_f32_32x32x16_bf16 a[48:63], v[92:95], v[104:107], a[48:63]
    s_waitcnt vmcnt(8)
    s_barrier
    ds_read_b128 v[88:91], v80 offset:32768
    ds_read_b128 v[92:95], v81 offset:32768
    ds_read_b128 v[100:103], v80 offset:49152
    ds_read_b128 v[104:107], v81 offset:49152
    s_add_u32 s59, s58, 0
    s_mov_b32 m0, s59
    s_mov_b32 s60, 0
    buffer_load_dwordx4 v22, s[20:23], s60 offen lds
    s_add_u32 s59, s58, 1024
    s_mov_b32 m0, s59
    s_mov_b32 s60, 0
    buffer_load_dwordx4 v23, s[20:23], s60 offen lds
    s_add_u32 s59, s58, 16384
    s_mov_b32 m0, s59
    s_mov_b32 s60, 0
    buffer_load_dwordx4 v26, s[12:15], s60 offen lds
    s_add_u32 s59, s58, 17408
    s_mov_b32 m0, s59
    s_mov_b32 s60, 0
    buffer_load_dwordx4 v27, s[12:15], s60 offen lds
    s_waitcnt lgkmcnt(0)
    v_mfma_f32_32x32x16_bf16 a[0:15], v[88:91], v[100:103], a[0:15]
    v_mfma_f32_32x32x16_bf16 a[16:31], v[88:91], v[104:107], a[16:31]
    v_mfma_f32_32x32x16_bf16 a[32:47], v[92:95], v[100:103], a[32:47]
    v_mfma_f32_32x32x16_bf16 a[48:63], v[92:95], v[104:107], a[48:63]
    s_waitcnt vmcnt(8)
    s_barrier
    ds_read_b128 v[88:91], v110 offset:0
    ds_read_b128 v[92:95], v111 offset:0
    ds_read_b128 v[100:103], v110 offset:16384
    ds_read_b128 v[104:107], v111 offset:16384
    s_add_u32 s59, s58, 32768
    s_mov_b32 m0, s59
    s_mov_b32 s60, 256
    buffer_load_dwordx4 v22, s[20:23], s60 offen lds
    s_add_u32 s59, s58, 33792
    s_mov_b32 m0, s59
    s_mov_b32 s60, 256
    buffer_load_dwordx4 v23, s[20:23], s60 offen lds
    s_add_u32 s59, s58, 49152
    s_mov_b32 m0, s59
    s_mov_b32 s60, 131072
    buffer_load_dwordx4 v26, s[12:15], s60 offen lds
    s_add_u32 s59, s58, 50176
    s_mov_b32 m0, s59
    s_mov_b32 s60, 131072
    buffer_load_dwordx4 v27, s[12:15], s60 offen lds
    s_waitcnt lgkmcnt(0)
    v_mfma_f32_32x32x16_bf16 a[0:15], v[88:91], v[100:103], a[0:15]
    v_mfma_f32_32x32x16_bf16 a[16:31], v[88:91], v[104:107], a[16:31]
    v_mfma_f32_32x32x16_bf16 a[32:47], v[92:95], v[100:103], a[32:47]
    v_mfma_f32_32x32x16_bf16 a[48:63], v[92:95], v[104:107], a[48:63]
    s_waitcnt vmcnt(8)
    s_barrier
    ds_read_b128 v[88:91], v110 offset:32768
    ds_read_b128 v[92:95], v111 offset:32768
    ds_read_b128 v[100:103], v110 offset:49152
    ds_read_b128 v[104:107], v111 offset:49152
    s_add_u32 s59, s58, 65536
    s_mov_b32 m0, s59
    s_mov_b32 s60, 512
    buffer_load_dwordx4 v22, s[20:23], s60 offen lds
    s_add_u32 s59, s58, 66560
    s_mov_b32 m0, s59
    s_mov_b32 s60, 512
    buffer_load_dwordx4 v23, s[20:23], s60 offen lds
    s_add_u32 s59, s58, 81920
    s_mov_b32 m0, s59
    s_mov_b32 s60, 262144
    buffer_load_dwordx4 v26, s[12:15], s60 offen lds
    s_add_u32 s59, s58, 82944
    s_mov_b32 m0, s59
    s_mov_b32 s60, 262144
    buffer_load_dwordx4 v27, s[12:15], s60 offen lds
    s_waitcnt lgkmcnt(0)
    v_mfma_f32_32x32x16_bf16 a[0:15], v[88:91], v[100:103], a[0:15]
    v_mfma_f32_32x32x16_bf16 a[16:31], v[88:91], v[104:107], a[16:31]
    v_mfma_f32_32x32x16_bf16 a[32:47], v[92:95], v[100:103], a[32:47]
    v_mfma_f32_32x32x16_bf16 a[48:63], v[92:95], v[104:107], a[48:63]
    s_waitcnt vmcnt(8)
    s_barrier
    ds_read_b128 v[88:91], v80 offset:0
    ds_read_b128 v[92:95], v81 offset:0
    ds_read_b64_tr_b16 v[100:101], v82 offset:0
    ds_read_b64_tr_b16 v[102:103], v84 offset:0
    ds_read_b64_tr_b16 v[104:105], v83 offset:0
    ds_read_b64_tr_b16 v[106:107], v85 offset:0
    s_add_u32 s59, s58, 98304
    s_mov_b32 m0, s59
    s_mov_b32 s60, 768
    buffer_load_dwordx4 v22, s[20:23], s60 offen lds
    s_add_u32 s59, s58, 99328
    s_mov_b32 m0, s59
    s_mov_b32 s60, 768
    buffer_load_dwordx4 v23, s[20:23], s60 offen lds
    s_add_u32 s59, s58, 114688
    s_mov_b32 m0, s59
    s_mov_b32 s60, 393216
    buffer_load_dwordx4 v26, s[12:15], s60 offen lds
    s_add_u32 s59, s58, 115712
    s_mov_b32 m0, s59
    s_mov_b32 s60, 393216
    buffer_load_dwordx4 v27, s[12:15], s60 offen lds
    s_waitcnt lgkmcnt(0)
    v_mfma_f32_32x32x16_bf16 a[64:79], v[88:91], v[100:103], a[64:79]
    v_mfma_f32_32x32x16_bf16 a[80:95], v[88:91], v[104:107], a[80:95]
    v_mfma_f32_32x32x16_bf16 a[96:111], v[92:95], v[100:103], a[96:111]
    v_mfma_f32_32x32x16_bf16 a[112:127], v[92:95], v[104:107], a[112:127]
    s_waitcnt vmcnt(8)
    s_barrier
    ds_read_b128 v[88:91], v80 offset:32768
    ds_read_b128 v[92:95], v81 offset:32768
    ds_read_b64_tr_b16 v[100:101], v82 offset:32768
    ds_read_b64_tr_b16 v[102:103], v84 offset:32768
    ds_read_b64_tr_b16 v[104:105], v83 offset:32768
    ds_read_b64_tr_b16 v[106:107], v85 offset:32768
    s_add_u32 s59, s58, 0
    s_mov_b32 m0, s59
    s_mov_b32 s60, 1024
    buffer_load_dwordx4 v22, s[20:23], s60 offen lds
    s_add_u32 s59, s58, 1024
    s_mov_b32 m0, s59
    s_mov_b32 s60, 1024
    buffer_load_dwordx4 v23, s[20:23], s60 offen lds
    s_add_u32 s59, s58, 16384
    s_mov_b32 m0, s59
    s_mov_b32 s60, 524288
    buffer_load_dwordx4 v26, s[12:15], s60 offen lds
    s_add_u32 s59, s58, 17408
    s_mov_b32 m0, s59
    s_mov_b32 s60, 524288
    buffer_load_dwordx4 v27, s[12:15], s60 offen lds
    s_waitcnt lgkmcnt(0)
    v_mfma_f32_32x32x16_bf16 a[64:79], v[88:91], v[100:103], a[64:79]
    v_mfma_f32_32x32x16_bf16 a[80:95], v[88:91], v[104:107], a[80:95]
    v_mfma_f32_32x32x16_bf16 a[96:111], v[92:95], v[100:103], a[96:111]
    v_mfma_f32_32x32x16_bf16 a[112:127], v[92:95], v[104:107], a[112:127]
    s_waitcnt vmcnt(8)
    s_barrier
    ds_read_b128 v[88:91], v110 offset:0
    ds_read_b128 v[92:95], v111 offset:0
    ds_read_b64_tr_b16 v[100:101], v112 offset:0
    ds_read_b64_tr_b16 v[102:103], v114 offset:0
    ds_read_b64_tr_b16 v[104:105], v113 offset:0
    ds_read_b64_tr_b16 v[106:107], v115 offset:0
    s_add_u32 s59, s58, 32768
    s_mov_b32 m0, s59
    s_mov_b32 s60, 1280
    buffer_load_dwordx4 v22, s[20:23], s60 offen lds
    s_add_u32 s59, s58, 33792
    s_mov_b32 m0, s59
    s_mov_b32 s60, 1280
    buffer_load_dwordx4 v23, s[20:23], s60 offen lds
    s_add_u32 s59, s58, 49152
    s_mov_b32 m0, s59
    s_mov_b32 s60, 655360
    buffer_load_dwordx4 v26, s[12:15], s60 offen lds
    s_add_u32 s59, s58, 50176
    s_mov_b32 m0, s59
    s_mov_b32 s60, 655360
    buffer_load_dwordx4 v27, s[12:15], s60 offen lds
    s_waitcnt lgkmcnt(0)
    v_mfma_f32_32x32x16_bf16 a[64:79], v[88:91], v[100:103], a[64:79]
    v_mfma_f32_32x32x16_bf16 a[80:95], v[88:91], v[104:107], a[80:95]
    v_mfma_f32_32x32x16_bf16 a[96:111], v[92:95], v[100:103], a[96:111]
    v_mfma_f32_32x32x16_bf16 a[112:127], v[92:95], v[104:107], a[112:127]
    s_waitcnt vmcnt(8)
    s_barrier
    ds_read_b128 v[88:91], v110 offset:32768
    ds_read_b128 v[92:95], v111 offset:32768
    ds_read_b64_tr_b16 v[100:101], v112 offset:32768
    ds_read_b64_tr_b16 v[102:103], v114 offset:32768
    ds_read_b64_tr_b16 v[104:105], v113 offset:32768
    ds_read_b64_tr_b16 v[106:107], v115 offset:32768
    s_add_u32 s59, s58, 65536
    s_mov_b32 m0, s59
    s_mov_b32 s60, 1536
    buffer_load_dwordx4 v22, s[20:23], s60 offen lds
    s_add_u32 s59, s58, 66560
    s_mov_b32 m0, s59
    s_mov_b32 s60, 1536
    buffer_load_dwordx4 v23, s[20:23], s60 offen lds
    s_add_u32 s59, s58, 81920
    s_mov_b32 m0, s59
    s_mov_b32 s60, 786432
    buffer_load_dwordx4 v26, s[12:15], s60 offen lds
    s_add_u32 s59, s58, 82944
    s_mov_b32 m0, s59
    s_mov_b32 s60, 786432
    buffer_load_dwordx4 v27, s[12:15], s60 offen lds
    s_waitcnt lgkmcnt(0)
    v_mfma_f32_32x32x16_bf16 a[64:79], v[88:91], v[100:103], a[64:79]
    v_mfma_f32_32x32x16_bf16 a[80:95], v[88:91], v[104:107], a[80:95]
    v_mfma_f32_32x32x16_bf16 a[96:111], v[92:95], v[100:103], a[96:111]
    v_mfma_f32_32x32x16_bf16 a[112:127], v[92:95], v[104:107], a[112:127]
    s_waitcnt vmcnt(8)
    s_barrier
    ds_read_b128 v[88:91], v80 offset:0
    ds_read_b128 v[92:95], v81 offset:0
    ds_read_b64_tr_b16 v[100:101], v82 offset:0
    ds_read_b64_tr_b16 v[102:103], v84 offset:0
    ds_read_b64_tr_b16 v[104:105], v83 offset:0
    ds_read_b64_tr_b16 v[106:107], v85 offset:0
    s_add_u32 s59, s58, 98304
    s_mov_b32 m0, s59
    s_mov_b32 s60, 1792
    buffer_load_dwordx4 v22, s[20:23], s60 offen lds
    s_add_u32 s59, s58, 99328
    s_mov_b32 m0, s59
    s_mov_b32 s60, 1792
    buffer_load_dwordx4 v23, s[20:23], s60 offen lds
    s_add_u32 s59, s58, 114688
    s_mov_b32 m0, s59
    s_mov_b32 s60, 917504
    buffer_load_dwordx4 v26, s[12:15], s60 offen lds
    s_add_u32 s59, s58, 115712
    s_mov_b32 m0, s59
    s_mov_b32 s60, 917504
    buffer_load_dwordx4 v27, s[12:15], s60 offen lds
    s_waitcnt lgkmcnt(0)
    v_mfma_f32_32x32x16_bf16 a[64:79], v[88:91], v[100:103], a[64:79]
    v_mfma_f32_32x32x16_bf16 a[80:95], v[88:91], v[104:107], a[80:95]
    v_mfma_f32_32x32x16_bf16 a[96:111], v[92:95], v[100:103], a[96:111]
    v_mfma_f32_32x32x16_bf16 a[112:127], v[92:95], v[104:107], a[112:127]
    s_waitcnt vmcnt(8)
    s_barrier
    ds_read_b128 v[88:91], v80 offset:32768
    ds_read_b128 v[92:95], v81 offset:32768
    ds_read_b64_tr_b16 v[100:101], v82 offset:32768
    ds_read_b64_tr_b16 v[102:103], v84 offset:32768
    ds_read_b64_tr_b16 v[104:105], v83 offset:32768
    ds_read_b64_tr_b16 v[106:107], v85 offset:32768
    s_add_u32 s59, s58, 0
    s_mov_b32 m0, s59
    s_mov_b32 s60, 2048
    buffer_load_dwordx4 v22, s[20:23], s60 offen lds
    s_add_u32 s59, s58, 1024
    s_mov_b32 m0, s59
    s_mov_b32 s60, 2048
    buffer_load_dwordx4 v23, s[20:23], s60 offen lds
    s_add_u32 s59, s58, 16384
    s_mov_b32 m0, s59
    s_mov_b32 s60, 1048576
    buffer_load_dwordx4 v26, s[12:15], s60 offen lds
    s_add_u32 s59, s58, 17408
    s_mov_b32 m0, s59
    s_mov_b32 s60, 1048576
    buffer_load_dwordx4 v27, s[12:15], s60 offen lds
    s_waitcnt lgkmcnt(0)
    v_mfma_f32_32x32x16_bf16 a[64:79], v[88:91], v[100:103], a[64:79]
    v_mfma_f32_32x32x16_bf16 a[80:95], v[88:91], v[104:107], a[80:95]
    v_mfma_f32_32x32x16_bf16 a[96:111], v[92:95], v[100:103], a[96:111]
    v_mfma_f32_32x32x16_bf16 a[112:127], v[92:95], v[104:107], a[112:127]
    s_waitcnt vmcnt(8)
    s_barrier
    ds_read_b128 v[88:91], v110 offset:0
    ds_read_b128 v[92:95], v111 offset:0
    ds_read_b64_tr_b16 v[100:101], v112 offset:0
    ds_read_b64_tr_b16 v[102:103], v114 offset:0
    ds_read_b64_tr_b16 v[104:105], v113 offset:0
    ds_read_b64_tr_b16 v[106:107], v115 offset:0
    s_add_u32 s59, s58, 32768
    s_mov_b32 m0, s59
    s_mov_b32 s60, 2304
    buffer_load_dwordx4 v22, s[20:23], s60 offen lds
    s_add_u32 s59, s58, 33792
    s_mov_b32 m0, s59
    s_mov_b32 s60, 2304
    buffer_load_dwordx4 v23, s[20:23], s60 offen lds
    s_add_u32 s59, s58, 49152
    s_mov_b32 m0, s59
    s_mov_b32 s60, 1179648
    buffer_load_dwordx4 v26, s[12:15], s60 offen lds
    s_add_u32 s59, s58, 50176
    s_mov_b32 m0, s59
    s_mov_b32 s60, 1179648
    buffer_load_dwordx4 v27, s[12:15], s60 offen lds
    s_waitcnt lgkmcnt(0)
    v_mfma_f32_32x32x16_bf16 a[64:79], v[88:91], v[100:103], a[64:79]
    v_mfma_f32_32x32x16_bf16 a[80:95], v[88:91], v[104:107], a[80:95]
    v_mfma_f32_32x32x16_bf16 a[96:111], v[92:95], v[100:103], a[96:111]
    v_mfma_f32_32x32x16_bf16 a[112:127], v[92:95], v[104:107], a[112:127]
    s_waitcnt vmcnt(8)
    s_barrier
    ds_read_b128 v[88:91], v110 offset:32768
    ds_read_b128 v[92:95], v111 offset:32768
    ds_read_b64_tr_b16 v[100:101], v112 offset:32768
    ds_read_b64_tr_b16 v[102:103], v114 offset:32768
    ds_read_b64_tr_b16 v[104:105], v113 offset:32768
    ds_read_b64_tr_b16 v[106:107], v115 offset:32768
    s_add_u32 s59, s58, 65536
    s_mov_b32 m0, s59
    s_mov_b32 s60, 2560
    buffer_load_dwordx4 v22, s[20:23], s60 offen lds
    s_add_u32 s59, s58, 66560
    s_mov_b32 m0, s59
    s_mov_b32 s60, 2560
    buffer_load_dwordx4 v23, s[20:23], s60 offen lds
    s_add_u32 s59, s58, 81920
    s_mov_b32 m0, s59
    s_mov_b32 s60, 1310720
    buffer_load_dwordx4 v26, s[12:15], s60 offen lds
    s_add_u32 s59, s58, 82944
    s_mov_b32 m0, s59
    s_mov_b32 s60, 1310720
    buffer_load_dwordx4 v27, s[12:15], s60 offen lds
    s_waitcnt lgkmcnt(0)
    v_mfma_f32_32x32x16_bf16 a[64:79], v[88:91], v[100:103], a[64:79]
    v_mfma_f32_32x32x16_bf16 a[80:95], v[88:91], v[104:107], a[80:95]
    v_mfma_f32_32x32x16_bf16 a[96:111], v[92:95], v[100:103], a[96:111]
    v_mfma_f32_32x32x16_bf16 a[112:127], v[92:95], v[104:107], a[112:127]
    s_waitcnt vmcnt(8)
    s_barrier
    ds_read_b128 v[88:91], v80 offset:0
    ds_read_b128 v[92:95], v81 offset:0
    ds_read_b64_tr_b16 v[100:101], v82 offset:0
    ds_read_b64_tr_b16 v[102:103], v84 offset:0
    ds_read_b64_tr_b16 v[104:105], v83 offset:0
    ds_read_b64_tr_b16 v[106:107], v85 offset:0
    s_add_u32 s59, s58, 98304
    s_mov_b32 m0, s59
    s_mov_b32 s60, 2816
    buffer_load_dwordx4 v22, s[20:23], s60 offen lds
    s_add_u32 s59, s58, 99328
    s_mov_b32 m0, s59
    s_mov_b32 s60, 2816
    buffer_load_dwordx4 v23, s[20:23], s60 offen lds
    s_add_u32 s59, s58, 114688
    s_mov_b32 m0, s59
    s_mov_b32 s60, 1441792
    buffer_load_dwordx4 v26, s[12:15], s60 offen lds
    s_add_u32 s59, s58, 115712
    s_mov_b32 m0, s59
    s_mov_b32 s60, 1441792
    buffer_load_dwordx4 v27, s[12:15], s60 offen lds
    s_waitcnt lgkmcnt(0)
    v_mfma_f32_32x32x16_bf16 a[64:79], v[88:91], v[100:103], a[64:79]
    v_mfma_f32_32x32x16_bf16 a[80:95], v[88:91], v[104:107], a[80:95]
    v_mfma_f32_32x32x16_bf16 a[96:111], v[92:95], v[100:103], a[96:111]
    v_mfma_f32_32x32x16_bf16 a[112:127], v[92:95], v[104:107], a[112:127]
    s_waitcnt vmcnt(8)
    s_barrier
    ds_read_b128 v[88:91], v80 offset:32768
    ds_read_b128 v[92:95], v81 offset:32768
    ds_read_b64_tr_b16 v[100:101], v82 offset:32768
    ds_read_b64_tr_b16 v[102:103], v84 offset:32768
    ds_read_b64_tr_b16 v[104:105], v83 offset:32768
    ds_read_b64_tr_b16 v[106:107], v85 offset:32768
    s_add_u32 s59, s58, 0
    s_mov_b32 m0, s59
    s_mov_b32 s60, 3072
    buffer_load_dwordx4 v22, s[20:23], s60 offen lds
    s_add_u32 s59, s58, 1024
    s_mov_b32 m0, s59
    s_mov_b32 s60, 3072
    buffer_load_dwordx4 v23, s[20:23], s60 offen lds
    s_add_u32 s59, s58, 16384
    s_mov_b32 m0, s59
    s_mov_b32 s60, 1572864
    buffer_load_dwordx4 v26, s[12:15], s60 offen lds
    s_add_u32 s59, s58, 17408
    s_mov_b32 m0, s59
    s_mov_b32 s60, 1572864
    buffer_load_dwordx4 v27, s[12:15], s60 offen lds
    s_waitcnt lgkmcnt(0)
    v_mfma_f32_32x32x16_bf16 a[64:79], v[88:91], v[100:103], a[64:79]
    v_mfma_f32_32x32x16_bf16 a[80:95], v[88:91], v[104:107], a[80:95]
    v_mfma_f32_32x32x16_bf16 a[96:111], v[92:95], v[100:103], a[96:111]
    v_mfma_f32_32x32x16_bf16 a[112:127], v[92:95], v[104:107], a[112:127]
    s_waitcnt vmcnt(8)
    s_barrier
    ds_read_b128 v[88:91], v110 offset:0
    ds_read_b128 v[92:95], v111 offset:0
    ds_read_b64_tr_b16 v[100:101], v112 offset:0
    ds_read_b64_tr_b16 v[102:103], v114 offset:0
    ds_read_b64_tr_b16 v[104:105], v113 offset:0
    ds_read_b64_tr_b16 v[106:107], v115 offset:0
    s_add_u32 s59, s58, 32768
    s_mov_b32 m0, s59
    s_mov_b32 s60, 3328
    buffer_load_dwordx4 v22, s[20:23], s60 offen lds
    s_add_u32 s59, s58, 33792
    s_mov_b32 m0, s59
    s_mov_b32 s60, 3328
    buffer_load_dwordx4 v23, s[20:23], s60 offen lds
    s_add_u32 s59, s58, 49152
    s_mov_b32 m0, s59
    s_mov_b32 s60, 1703936
    buffer_load_dwordx4 v26, s[12:15], s60 offen lds
    s_add_u32 s59, s58, 50176
    s_mov_b32 m0, s59
    s_mov_b32 s60, 1703936
    buffer_load_dwordx4 v27, s[12:15], s60 offen lds
    s_waitcnt lgkmcnt(0)
    v_mfma_f32_32x32x16_bf16 a[64:79], v[88:91], v[100:103], a[64:79]
    v_mfma_f32_32x32x16_bf16 a[80:95], v[88:91], v[104:107], a[80:95]
    v_mfma_f32_32x32x16_bf16 a[96:111], v[92:95], v[100:103], a[96:111]
    v_mfma_f32_32x32x16_bf16 a[112:127], v[92:95], v[104:107], a[112:127]
    s_waitcnt vmcnt(8)
    s_barrier
    ds_read_b128 v[88:91], v110 offset:32768
    ds_read_b128 v[92:95], v111 offset:32768
    ds_read_b64_tr_b16 v[100:101], v112 offset:32768
    ds_read_b64_tr_b16 v[102:103], v114 offset:32768
    ds_read_b64_tr_b16 v[104:105], v113 offset:32768
    ds_read_b64_tr_b16 v[106:107], v115 offset:32768
    s_waitcnt lgkmcnt(0)
    v_mfma_f32_32x32x16_bf16 a[64:79], v[88:91], v[100:103], a[64:79]
    v_mfma_f32_32x32x16_bf16 a[80:95], v[88:91], v[104:107], a[80:95]
    v_mfma_f32_32x32x16_bf16 a[96:111], v[92:95], v[100:103], a[96:111]
    v_mfma_f32_32x32x16_bf16 a[112:127], v[92:95], v[104:107], a[112:127]
    s_waitcnt vmcnt(4)
    s_barrier
    ds_read_b128 v[88:91], v80 offset:0
    ds_read_b128 v[92:95], v81 offset:0
    ds_read_b64_tr_b16 v[100:101], v82 offset:0
    ds_read_b64_tr_b16 v[102:103], v84 offset:0
    ds_read_b64_tr_b16 v[104:105], v83 offset:0
    ds_read_b64_tr_b16 v[106:107], v85 offset:0
    s_waitcnt lgkmcnt(0)
    v_mfma_f32_32x32x16_bf16 a[64:79], v[88:91], v[100:103], a[64:79]
    v_mfma_f32_32x32x16_bf16 a[80:95], v[88:91], v[104:107], a[80:95]
    v_mfma_f32_32x32x16_bf16 a[96:111], v[92:95], v[100:103], a[96:111]
    v_mfma_f32_32x32x16_bf16 a[112:127], v[92:95], v[104:107], a[112:127]
    s_waitcnt vmcnt(0)
    s_barrier
    ds_read_b128 v[88:91], v80 offset:32768
    ds_read_b128 v[92:95], v81 offset:32768
    ds_read_b64_tr_b16 v[100:101], v82 offset:32768
    ds_read_b64_tr_b16 v[102:103], v84 offset:32768
    ds_read_b64_tr_b16 v[104:105], v83 offset:32768
    ds_read_b64_tr_b16 v[106:107], v85 offset:32768
    s_waitcnt lgkmcnt(0)
    v_mfma_f32_32x32x16_bf16 a[64:79], v[88:91], v[100:103], a[64:79]
    v_mfma_f32_32x32x16_bf16 a[80:95], v[88:91], v[104:107], a[80:95]
    v_mfma_f32_32x32x16_bf16 a[96:111], v[92:95], v[100:103], a[96:111]
    v_mfma_f32_32x32x16_bf16 a[112:127], v[92:95], v[104:107], a[112:127]
    s_nop 7
    s_nop 7
    s_barrier
    v_lshlrev_b32 v16, 4, v2
    s_lshl_b32 s7, s5, 14
    v_add_u32 v17, s7, v16
    s_lshl_b32 s7, s5, 11
    v_add_u32 v18, s7, v16
    v_add_u32 v19, 65536, v18
    ds_write_b128 v17, a[0:3] offset:0
    ds_write_b128 v17, a[4:7] offset:1024
    ds_write_b128 v17, a[8:11] offset:2048
    ds_write_b128 v17, a[12:15] offset:3072
    ds_write_b128 v17, a[16:19] offset:4096
    ds_write_b128 v17, a[20:23] offset:5120
    ds_write_b128 v17, a[24:27] offset:6144
    ds_write_b128 v17, a[28:31] offset:7168
    ds_write_b128 v17, a[32:35] offset:8192
    ds_write_b128 v17, a[36:39] offset:9216
    ds_write_b128 v17, a[40:43] offset:10240
    ds_write_b128 v17, a[44:47] offset:11264
    ds_write_b128 v17, a[48:51] offset:12288
    ds_write_b128 v17, a[52:55] offset:13312
    ds_write_b128 v17, a[56:59] offset:14336
    ds_write_b128 v17, a[60:63] offset:15360
    s_waitcnt lgkmcnt(0)
    s_barrier
    ds_read_b128 v[28:31], v18 offset:0
    ds_read_b128 v[32:35], v18 offset:1024
    ds_read_b128 v[36:39], v18 offset:16384
    ds_read_b128 v[40:43], v18 offset:17408
    ds_read_b128 v[44:47], v18 offset:32768
    ds_read_b128 v[48:51], v18 offset:33792
    ds_read_b128 v[52:55], v18 offset:49152
    ds_read_b128 v[56:59], v18 offset:50176
    ds_read_b128 v[60:63], v19 offset:0
    ds_read_b128 v[64:67], v19 offset:1024
    ds_read_b128 v[68:71], v19 offset:16384
    ds_read_b128 v[72:75], v19 offset:17408
    ds_read_b128 v[76:79], v19 offset:32768
    ds_read_b128 v[80:83], v19 offset:33792
    ds_read_b128 v[84:87], v19 offset:49152
    ds_read_b128 v[88:91], v19 offset:50176
    s_waitcnt lgkmcnt(0)
    v_add_f32 v28, v28, v36
    v_add_f32 v44, v44, v52
    v_add_f32 v60, v60, v68
    v_add_f32 v76, v76, v84
    v_add_f32 v28, v28, v44
    v_add_f32 v60, v60, v76
    v_add_f32 v104, v28, v60
    v_add_f32 v29, v29, v37
    v_add_f32 v45, v45, v53
    v_add_f32 v61, v61, v69
    v_add_f32 v77, v77, v85
    v_add_f32 v29, v29, v45
    v_add_f32 v61, v61, v77
    v_add_f32 v105, v29, v61
    v_add_f32 v30, v30, v38
    v_add_f32 v46, v46, v54
    v_add_f32 v62, v62, v70
    v_add_f32 v78, v78, v86
    v_add_f32 v30, v30, v46
    v_add_f32 v62, v62, v78
    v_add_f32 v106, v30, v62
    v_add_f32 v31, v31, v39
    v_add_f32 v47, v47, v55
    v_add_f32 v63, v63, v71
    v_add_f32 v79, v79, v87
    v_add_f32 v31, v31, v47
    v_add_f32 v63, v63, v79
    v_add_f32 v107, v31, v63
    v_add_f32 v32, v32, v40
    v_add_f32 v48, v48, v56
    v_add_f32 v64, v64, v72
    v_add_f32 v80, v80, v88
    v_add_f32 v32, v32, v48
    v_add_f32 v64, v64, v80
    v_add_f32 v108, v32, v64
    v_add_f32 v33, v33, v41
    v_add_f32 v49, v49, v57
    v_add_f32 v65, v65, v73
    v_add_f32 v81, v81, v89
    v_add_f32 v33, v33, v49
    v_add_f32 v65, v65, v81
    v_add_f32 v109, v33, v65
    v_add_f32 v34, v34, v42
    v_add_f32 v50, v50, v58
    v_add_f32 v66, v66, v74
    v_add_f32 v82, v82, v90
    v_add_f32 v34, v34, v50
    v_add_f32 v66, v66, v82
    v_add_f32 v110, v34, v66
    v_add_f32 v35, v35, v43
    v_add_f32 v51, v51, v59
    v_add_f32 v67, v67, v75
    v_add_f32 v83, v83, v91
    v_add_f32 v35, v35, v51
    v_add_f32 v67, v67, v83
    v_add_f32 v111, v35, v67
    s_barrier
    ds_write_b128 v17, a[64:67] offset:0
    ds_write_b128 v17, a[68:71] offset:1024
    ds_write_b128 v17, a[72:75] offset:2048
    ds_write_b128 v17, a[76:79] offset:3072
    ds_write_b128 v17, a[80:83] offset:4096
    ds_write_b128 v17, a[84:87] offset:5120
    ds_write_b128 v17, a[88:91] offset:6144
    ds_write_b128 v17, a[92:95] offset:7168
    ds_write_b128 v17, a[96:99] offset:8192
    ds_write_b128 v17, a[100:103] offset:9216
    ds_write_b128 v17, a[104:107] offset:10240
    ds_write_b128 v17, a[108:111] offset:11264
    ds_write_b128 v17, a[112:115] offset:12288
    ds_write_b128 v17, a[116:119] offset:13312
    ds_write_b128 v17, a[120:123] offset:14336
    ds_write_b128 v17, a[124:127] offset:15360
    s_waitcnt lgkmcnt(0)
    s_barrier
    ds_read_b128 v[28:31], v18 offset:0
    ds_read_b128 v[32:35], v18 offset:1024
    ds_read_b128 v[36:39], v18 offset:16384
    ds_read_b128 v[40:43], v18 offset:17408
    ds_read_b128 v[44:47], v18 offset:32768
    ds_read_b128 v[48:51], v18 offset:33792
    ds_read_b128 v[52:55], v18 offset:49152
    ds_read_b128 v[56:59], v18 offset:50176
    ds_read_b128 v[60:63], v19 offset:0
    ds_read_b128 v[64:67], v19 offset:1024
    ds_read_b128 v[68:71], v19 offset:16384
    ds_read_b128 v[72:75], v19 offset:17408
    ds_read_b128 v[76:79], v19 offset:32768
    ds_read_b128 v[80:83], v19 offset:33792
    ds_read_b128 v[84:87], v19 offset:49152
    ds_read_b128 v[88:91], v19 offset:50176
    s_waitcnt lgkmcnt(0)
    v_add_f32 v28, v28, v36
    v_add_f32 v44, v44, v52
    v_add_f32 v60, v60, v68
    v_add_f32 v76, v76, v84
    v_add_f32 v28, v28, v44
    v_add_f32 v60, v60, v76
    v_add_f32 v112, v28, v60
    v_add_f32 v29, v29, v37
    v_add_f32 v45, v45, v53
    v_add_f32 v61, v61, v69
    v_add_f32 v77, v77, v85
    v_add_f32 v29, v29, v45
    v_add_f32 v61, v61, v77
    v_add_f32 v113, v29, v61
    v_add_f32 v30, v30, v38
    v_add_f32 v46, v46, v54
    v_add_f32 v62, v62, v70
    v_add_f32 v78, v78, v86
    v_add_f32 v30, v30, v46
    v_add_f32 v62, v62, v78
    v_add_f32 v114, v30, v62
    v_add_f32 v31, v31, v39
    v_add_f32 v47, v47, v55
    v_add_f32 v63, v63, v71
    v_add_f32 v79, v79, v87
    v_add_f32 v31, v31, v47
    v_add_f32 v63, v63, v79
    v_add_f32 v115, v31, v63
    v_add_f32 v32, v32, v40
    v_add_f32 v48, v48, v56
    v_add_f32 v64, v64, v72
    v_add_f32 v80, v80, v88
    v_add_f32 v32, v32, v48
    v_add_f32 v64, v64, v80
    v_add_f32 v116, v32, v64
    v_add_f32 v33, v33, v41
    v_add_f32 v49, v49, v57
    v_add_f32 v65, v65, v73
    v_add_f32 v81, v81, v89
    v_add_f32 v33, v33, v49
    v_add_f32 v65, v65, v81
    v_add_f32 v117, v33, v65
    v_add_f32 v34, v34, v42
    v_add_f32 v50, v50, v58
    v_add_f32 v66, v66, v74
    v_add_f32 v82, v82, v90
    v_add_f32 v34, v34, v50
    v_add_f32 v66, v66, v82
    v_add_f32 v118, v34, v66
    v_add_f32 v35, v35, v43
    v_add_f32 v51, v51, v59
    v_add_f32 v67, v67, v75
    v_add_f32 v83, v83, v91
    v_add_f32 v35, v35, v51
    v_add_f32 v67, v67, v83
    v_add_f32 v119, v35, v67
    s_mov_b32 s8, s24
    s_mov_b32 s9, s25
    s_mov_b32 s10, 2097152
    s_mov_b32 s11, 0x00020000
    s_mov_b32 s48, s32
    s_mov_b32 s49, s33
    s_mov_b32 s50, 1024
    s_mov_b32 s51, 0x00020000
    s_mov_b32 s52, s38
    s_mov_b32 s53, s39
    s_mov_b32 s54, 1024
    s_mov_b32 s55, 0x00020000
    s_mov_b32 s56, s40
    s_mov_b32 s57, s41
    s_mov_b32 s58, 4194304
    s_mov_b32 s59, 0x00020000
    s_lshr_b32 s6, s5, 1
    s_and_b32 s6, s6, 1
    s_lshl_b32 s6, s6, 5
    s_lshl_b32 s7, s4, 6
    s_add_u32 s6, s6, s7
    v_add_u32 v30, s6, v3
    s_lshr_b32 s6, s5, 2
    s_lshl_b32 s6, s6, 5
    s_and_b32 s7, s5, 1
    s_lshl_b32 s7, s7, 4
    s_add_u32 s6, s6, s7
    s_lshl_b32 s7, s3, 6
    s_add_u32 s6, s6, s7
    v_lshl_add_u32 v31, v4, 2, s6
    v_lshlrev_b32 v32, 1, v30
    buffer_load_ushort v33, v32, s[48:51], 0 offen
    buffer_load_ushort v34, v32, s[52:55], 0 offen
    v_lshlrev_b32 v35, 10, v31
    v_add_u32 v35, v35, v32
    v_lshlrev_b32 v36, 2, v31
    v_add_u32 v36, 13631488, v36
    v_lshlrev_b32 v37, 1, v35
    buffer_load_ushort v40, v35, s[8:11], 0 offen offset:0
    buffer_load_dword v50, v36, s[20:23], 0 offen offset:0
    buffer_load_ushort v41, v35, s[8:11], 0 offen offset:1024
    buffer_load_dword v51, v36, s[20:23], 0 offen offset:4
    buffer_load_ushort v42, v35, s[8:11], 0 offen offset:2048
    buffer_load_dword v52, v36, s[20:23], 0 offen offset:8
    buffer_load_ushort v43, v35, s[8:11], 0 offen offset:3072
    buffer_load_dword v53, v36, s[20:23], 0 offen offset:12
    v_add_u32 v38, 8192, v35
    buffer_load_ushort v44, v38, s[8:11], 0 offen
    buffer_load_dword v54, v36, s[20:23], 0 offen offset:32
    v_add_u32 v38, 9216, v35
    buffer_load_ushort v45, v38, s[8:11], 0 offen
    buffer_load_dword v55, v36, s[20:23], 0 offen offset:36
    v_add_u32 v38, 10240, v35
    buffer_load_ushort v46, v38, s[8:11], 0 offen
    buffer_load_dword v56, v36, s[20:23], 0 offen offset:40
    v_add_u32 v38, 11264, v35
    buffer_load_ushort v47, v38, s[8:11], 0 offen
    buffer_load_dword v57, v36, s[20:23], 0 offen offset:44
    s_waitcnt vmcnt(0)
    v_lshlrev_b32 v33, 16, v33
    v_lshlrev_b32 v34, 16, v34
    v_lshlrev_b32 v60, 16, v40
    v_mul_f32 v60, v60, v33
    v_cvt_pk_bf16_f32 v60, v60, v60
    v_lshlrev_b32 v60, 16, v60
    v_fma_f32 v60, 2.0, v104, v60
    v_cvt_pk_bf16_f32 v61, v112, v112
    v_lshlrev_b32 v61, 16, v61
    v_add_f32 v61, v61, v34
    v_cvt_pk_bf16_f32 v61, v61, v61
    v_lshlrev_b32 v61, 16, v61
    v_sub_f32 v62, 1.0, v50
    v_cvt_pk_bf16_f32 v62, v62, v62
    v_lshlrev_b32 v62, 16, v62
    v_mul_f32 v61, v61, v62
    v_cvt_pk_bf16_f32 v61, v61, v61
    v_lshlrev_b32 v61, 16, v61
    v_fma_f32 v64, v50, v60, v61
    v_add_u32 v38, 0, v37
    buffer_store_dword v64, v38, s[56:59], 0 offen
    v_lshlrev_b32 v60, 16, v41
    v_mul_f32 v60, v60, v33
    v_cvt_pk_bf16_f32 v60, v60, v60
    v_lshlrev_b32 v60, 16, v60
    v_fma_f32 v60, 2.0, v105, v60
    v_cvt_pk_bf16_f32 v61, v113, v113
    v_lshlrev_b32 v61, 16, v61
    v_add_f32 v61, v61, v34
    v_cvt_pk_bf16_f32 v61, v61, v61
    v_lshlrev_b32 v61, 16, v61
    v_sub_f32 v62, 1.0, v51
    v_cvt_pk_bf16_f32 v62, v62, v62
    v_lshlrev_b32 v62, 16, v62
    v_mul_f32 v61, v61, v62
    v_cvt_pk_bf16_f32 v61, v61, v61
    v_lshlrev_b32 v61, 16, v61
    v_fma_f32 v65, v51, v60, v61
    v_add_u32 v38, 2048, v37
    buffer_store_dword v65, v38, s[56:59], 0 offen
    v_lshlrev_b32 v60, 16, v42
    v_mul_f32 v60, v60, v33
    v_cvt_pk_bf16_f32 v60, v60, v60
    v_lshlrev_b32 v60, 16, v60
    v_fma_f32 v60, 2.0, v106, v60
    v_cvt_pk_bf16_f32 v61, v114, v114
    v_lshlrev_b32 v61, 16, v61
    v_add_f32 v61, v61, v34
    v_cvt_pk_bf16_f32 v61, v61, v61
    v_lshlrev_b32 v61, 16, v61
    v_sub_f32 v62, 1.0, v52
    v_cvt_pk_bf16_f32 v62, v62, v62
    v_lshlrev_b32 v62, 16, v62
    v_mul_f32 v61, v61, v62
    v_cvt_pk_bf16_f32 v61, v61, v61
    v_lshlrev_b32 v61, 16, v61
    v_fma_f32 v66, v52, v60, v61
    v_add_u32 v38, 4096, v37
    buffer_store_dword v66, v38, s[56:59], 0 offen
    v_lshlrev_b32 v60, 16, v43
    v_mul_f32 v60, v60, v33
    v_cvt_pk_bf16_f32 v60, v60, v60
    v_lshlrev_b32 v60, 16, v60
    v_fma_f32 v60, 2.0, v107, v60
    v_cvt_pk_bf16_f32 v61, v115, v115
    v_lshlrev_b32 v61, 16, v61
    v_add_f32 v61, v61, v34
    v_cvt_pk_bf16_f32 v61, v61, v61
    v_lshlrev_b32 v61, 16, v61
    v_sub_f32 v62, 1.0, v53
    v_cvt_pk_bf16_f32 v62, v62, v62
    v_lshlrev_b32 v62, 16, v62
    v_mul_f32 v61, v61, v62
    v_cvt_pk_bf16_f32 v61, v61, v61
    v_lshlrev_b32 v61, 16, v61
    v_fma_f32 v67, v53, v60, v61
    v_add_u32 v38, 6144, v37
    buffer_store_dword v67, v38, s[56:59], 0 offen
    v_lshlrev_b32 v60, 16, v44
    v_mul_f32 v60, v60, v33
    v_cvt_pk_bf16_f32 v60, v60, v60
    v_lshlrev_b32 v60, 16, v60
    v_fma_f32 v60, 2.0, v108, v60
    v_cvt_pk_bf16_f32 v61, v116, v116
    v_lshlrev_b32 v61, 16, v61
    v_add_f32 v61, v61, v34
    v_cvt_pk_bf16_f32 v61, v61, v61
    v_lshlrev_b32 v61, 16, v61
    v_sub_f32 v62, 1.0, v54
    v_cvt_pk_bf16_f32 v62, v62, v62
    v_lshlrev_b32 v62, 16, v62
    v_mul_f32 v61, v61, v62
    v_cvt_pk_bf16_f32 v61, v61, v61
    v_lshlrev_b32 v61, 16, v61
    v_fma_f32 v68, v54, v60, v61
    v_add_u32 v38, 16384, v37
    buffer_store_dword v68, v38, s[56:59], 0 offen
    v_lshlrev_b32 v60, 16, v45
    v_mul_f32 v60, v60, v33
    v_cvt_pk_bf16_f32 v60, v60, v60
    v_lshlrev_b32 v60, 16, v60
    v_fma_f32 v60, 2.0, v109, v60
    v_cvt_pk_bf16_f32 v61, v117, v117
    v_lshlrev_b32 v61, 16, v61
    v_add_f32 v61, v61, v34
    v_cvt_pk_bf16_f32 v61, v61, v61
    v_lshlrev_b32 v61, 16, v61
    v_sub_f32 v62, 1.0, v55
    v_cvt_pk_bf16_f32 v62, v62, v62
    v_lshlrev_b32 v62, 16, v62
    v_mul_f32 v61, v61, v62
    v_cvt_pk_bf16_f32 v61, v61, v61
    v_lshlrev_b32 v61, 16, v61
    v_fma_f32 v69, v55, v60, v61
    v_add_u32 v38, 18432, v37
    buffer_store_dword v69, v38, s[56:59], 0 offen
    v_lshlrev_b32 v60, 16, v46
    v_mul_f32 v60, v60, v33
    v_cvt_pk_bf16_f32 v60, v60, v60
    v_lshlrev_b32 v60, 16, v60
    v_fma_f32 v60, 2.0, v110, v60
    v_cvt_pk_bf16_f32 v61, v118, v118
    v_lshlrev_b32 v61, 16, v61
    v_add_f32 v61, v61, v34
    v_cvt_pk_bf16_f32 v61, v61, v61
    v_lshlrev_b32 v61, 16, v61
    v_sub_f32 v62, 1.0, v56
    v_cvt_pk_bf16_f32 v62, v62, v62
    v_lshlrev_b32 v62, 16, v62
    v_mul_f32 v61, v61, v62
    v_cvt_pk_bf16_f32 v61, v61, v61
    v_lshlrev_b32 v61, 16, v61
    v_fma_f32 v70, v56, v60, v61
    v_add_u32 v38, 20480, v37
    buffer_store_dword v70, v38, s[56:59], 0 offen
    v_lshlrev_b32 v60, 16, v47
    v_mul_f32 v60, v60, v33
    v_cvt_pk_bf16_f32 v60, v60, v60
    v_lshlrev_b32 v60, 16, v60
    v_fma_f32 v60, 2.0, v111, v60
    v_cvt_pk_bf16_f32 v61, v119, v119
    v_lshlrev_b32 v61, 16, v61
    v_add_f32 v61, v61, v34
    v_cvt_pk_bf16_f32 v61, v61, v61
    v_lshlrev_b32 v61, 16, v61
    v_sub_f32 v62, 1.0, v57
    v_cvt_pk_bf16_f32 v62, v62, v62
    v_lshlrev_b32 v62, 16, v62
    v_mul_f32 v61, v61, v62
    v_cvt_pk_bf16_f32 v61, v61, v61
    v_lshlrev_b32 v61, 16, v61
    v_fma_f32 v71, v57, v60, v61
    v_add_u32 v38, 22528, v37
    buffer_store_dword v71, v38, s[56:59], 0 offen
K2_END:
    s_endpgm
.section .rodata,"a"
.p2align 6
.amdhsa_kernel k2_kernel
  .amdhsa_next_free_vgpr 248
  .amdhsa_next_free_sgpr 102
  .amdhsa_accum_offset 120
  .amdhsa_group_segment_fixed_size 0
  .amdhsa_kernarg_size 144
  .amdhsa_user_sgpr_count 2
  .amdhsa_user_sgpr_kernarg_segment_ptr 1
  .amdhsa_system_sgpr_workgroup_id_x 1
.end_amdhsa_kernel
.text
```
